```python
import torch

def _softmax(x, axis=-1):
    return torch.softmax(x, dim=axis)
def _gelu(x):
    return torch.nn.functional.gelu(x, approximate="tanh")
def _silu(x):
    return torch.nn.functional.silu(x)
def _sigmoid(x):
    return torch.sigmoid(x)
def _layernorm(x, axis=-1, eps=1e-5):
    m = x.mean(dim=axis, keepdim=True)
    v = x.var(dim=axis, keepdim=True, unbiased=False)
    return (x - m) / torch.sqrt(v + eps)
def _scatter_add(tgt, idx, src, axis=0):
    return tgt.clone().index_add_(axis, idx, src)
def _segment_sum(src, seg, n):
    out = torch.zeros((n,) + src.shape[1:], dtype=src.dtype)
    return out.index_add_(0, seg, src)
def _pad(x, pw):
    flat = tuple(v for pair in reversed(pw) for v in pair)
    return torch.nn.functional.pad(x, flat)

kernel_name = 'gated_mix__spectral_gfnet__glu_gated_geglu__prompt'

def setup_inputs():

    _w = (lambda a: (lambda t: t.to(torch.bfloat16) if t.is_floating_point() else t)(torch.as_tensor(a)))
    def _A_setup():
        B, S, D = 1, 2048, 512
        Df = D // 2 + 1
        return {
            "x": _w((lambda *s: torch.randn(*s, dtype=torch.bfloat16) * 0.05)(B, S, D)),
            "w_r": _w((lambda *s: torch.randn(*s, dtype=torch.bfloat16) * 0.05)(S, Df) * 0.02),
            "w_i": _w((lambda *s: torch.randn(*s, dtype=torch.bfloat16) * 0.05)(S, Df) * 0.02),
        }
    _A_in = _A_setup()

    def _B_setup():
        B, S, Dm, Df = 1, 2048, 512, 1792
        return {
            "x": _w((lambda *s: torch.randn(*s, dtype=torch.bfloat16) * 0.05)(B, S, Dm)),
            "w_gate": _w((lambda *s: torch.randn(*s, dtype=torch.bfloat16) * 0.2)(Dm, Df) * (Dm ** -0.5)),
            "w_up": _w((lambda *s: torch.randn(*s, dtype=torch.bfloat16) * 0.2)(Dm, Df) * (Dm ** -0.5)),
            "w_down": _w((lambda *s: torch.randn(*s, dtype=torch.bfloat16) * 0.2)(Df, Dm) * (Df ** -0.5)),
        }
    _B_in = _B_setup()

    return {
        "A_x": _A_in["x"],
        "A_w_r": _A_in["w_r"],
        "A_w_i": _A_in["w_i"],
        "B_x": _B_in["x"],
        "B_w_gate": _B_in["w_gate"],
        "B_w_up": _B_in["w_up"],
        "B_w_down": _B_in["w_down"],
        "gate_w": _w((lambda *s: torch.randn(*s, dtype=torch.bfloat16) * 0.05)(512) * 16.0),
    }

def reference(A_x, A_w_r, A_w_i, B_x, B_w_gate, B_w_up, B_w_down, gate_w):
    def _A_ref(x, w_r, w_i):
        B, S, D = x.shape
        X = (lambda x, axes=(-2,-1): torch.fft.rfft2(x.float(), dim=axes))(x, axes=(-2, -1))
        W = w_r + 1j * w_i
        X = X * W
        y = (lambda x, s, axes=(-2,-1): torch.fft.irfft2(x, s=s, dim=axes).to(torch.bfloat16))(X, (S, D), axes=(-2, -1))
        return y

    def _B_ref(x, w_gate, w_up, w_down):
        g = torch.einsum("bsd,df->bsf", x, w_gate)
        u = torch.einsum("bsd,df->bsf", x, w_up)
        h = _gelu(g) * u
        return torch.einsum("bsf,fd->bsd", h, w_down)

    x = A_x
    g = _sigmoid((x * gate_w).sum(-1, keepdims=True))
    a = _A_ref(x, A_w_r, A_w_i)
    b = _B_ref(x, B_w_gate, B_w_up, B_w_down)
    return g * a + (1 - g) * b
```

```asm
; @launch grid=(256,1,1) block=(256,1,1) lds=163840
.amdgcn_target "amdgcn-amd-amdhsa--gfx950"
.text
.globl gated_mix__spectral_gfnet__glu_gated_geglu__prompt_kernel
.p2align 8
.type gated_mix__spectral_gfnet__glu_gated_geglu__prompt_kernel,@function
gated_mix__spectral_gfnet__glu_gated_geglu__prompt_kernel:
    s_cmp_ge_u32 s2, 256
    s_cbranch_scc1 L_end
    s_load_dwordx2 s[4:5], s[0:1], 0
    s_load_dwordx8 s[8:15], s[0:1], 32
    s_load_dwordx2 s[20:21], s[0:1], 80
    s_load_dwordx2 s[32:33], s[0:1], 8
    s_load_dwordx2 s[36:37], s[0:1], 16
    s_load_dwordx2 s[24:25], s[0:1], 64
    s_lshr_b32 s59, s2, 3
    s_getpc_b64 s[66:67]
L_pc:
    s_lshl_b32 s58, s59, 11
    v_lshrrev_b32 v8, 3, v0
    v_lshl_add_u32 v8, v8, 6, s58
    v_mov_b32 v9, s67
    v_min_u32 v8, L_codeend-L_pc, v8
    v_add_co_u32 v8, vcc, s66, v8
    v_lshrrev_b32 v5, 6, v0
    v_and_b32 v0, 63, v0
    v_addc_co_u32 v9, vcc, 0, v9, vcc
    global_load_dword v255, v[8:9], off
    v_readfirstlane_b32 s42, v5
    v_lshrrev_b32 v128, 4, v0
    v_and_b32 v129, 15, v0
    s_and_b32 s45, s2, 3
    s_and_b32 s58, s2, 4
    v_xor_b32 v131, v129, v128
    s_lshr_b32 s44, s59, 2
    s_and_b32 s59, s59, 3
    v_lshlrev_b32 v131, 4, v131
    s_add_u32 s46, s58, s59
    s_lshl_b32 s46, s46, 2
    v_lshl_add_u32 v8, v128, 15, v131
    s_add_u32 s43, s46, s45
    s_lshl_b32 s59, s59, 1
    s_add_u32 s57, s59, s44
    s_and_b32 s57, s57, 3
    s_lshl_b32 s52, s42, 12
    s_lshl_b32 s50, s42, 19
    s_lshl_b32 s58, s43, 10
    s_add_u32 s50, s50, s58
    s_lshl_b32 s28, s57, 8
    v_xor_b32 v130, 64, v8
    v_xor_b32 v131, 128, v8
    v_xor_b32 v132, 192, v8
    v_add_u32 v9, 130048, v130
    v_add_u32 v10, 260096, v131
    v_add_u32 v11, 390144, v132
    s_mov_b32 s6, 2097152
    s_mov_b32 s7, 0x20000
    s_add_u32 m0, s52, 0
    s_add_u32 s58, s50, s28
    s_waitcnt lgkmcnt(0)
    buffer_load_dwordx4 v8, s[4:7], s58 offen lds
    v_lshlrev_b32 v1, 4, v0
    s_lshr_b32 s48, s42, 1
    s_and_b32 s49, s42, 1
    s_lshl_b32 s56, s42, 14
    s_add_u32 s29, s28, 256
    buffer_load_dwordx4 v9, s[4:7], s58 offen offset:1024 lds
    s_and_b32 s29, s29, 1023
    s_add_u32 s30, s29, 256
    s_and_b32 s30, s30, 1023
    s_add_u32 s31, s30, 256
    s_and_b32 s31, s31, 1023
    buffer_load_dwordx4 v10, s[4:7], s58 offen offset:2048 lds
    s_mov_b32 s22, 268435456
    s_mov_b32 s23, 0x20000
    s_mov_b32 s26, 0x200000
    s_mov_b32 s27, 0x20000
    buffer_load_dwordx4 v11, s[4:7], s58 offen offset:3072 lds
    s_cmp_eq_u32 s44, 7
    s_cbranch_scc1 L_p2
    v_lshrrev_b32 v150, 3, v0
    v_and_b32 v151, 7, v0
    v_and_b32 v152, 2, v150
    v_lshlrev_b32 v5, 1, v152
    buffer_load_dwordx2 v[6:7], off, s[20:23], 0 sc1
    v_xor_b32 v5, v5, v151
    v_lshlrev_b32 v5, 4, v5
    v_lshl_add_u32 v5, v150, 10, v5
    v_xor_b32 v151, v151, v152
    v_mul_u32_u24 v150, 3584, v150
    v_lshl_add_u32 v20, v151, 4, v150
    v_xor_b32 v151, 4, v151
    v_lshl_add_u32 v21, v151, 4, v150
    s_add_u32 m0, s52, 16384
    s_add_u32 s58, s50, s29
    buffer_load_dwordx4 v8, s[4:7], s58 offen lds
    v_add_u32 v22, 26624, v20
    v_add_u32 v23, 26624, v21
    s_mul_i32 s47, s45, 7
    s_add_u32 s47, s47, s44
    s_mul_i32 s51, s42, 57344
    s_lshl_b32 s38, s47, 7
    s_add_u32 s51, s51, s38
    s_add_u32 s38, s51, 229376
    buffer_load_dwordx4 v9, s[4:7], s58 offen offset:1024 lds
    s_mov_b32 s64, s12
    s_mov_b32 s65, s13
    s_mov_b32 s66, 1835008
    s_mov_b32 s67, 0x20000
    s_sub_u32 s12, s10, 1024
    s_subb_u32 s13, s11, 0
    s_mov_b32 s10, 1835008
    s_mov_b32 s14, 1836032
    buffer_load_dwordx4 v10, s[4:7], s58 offen offset:2048 lds
    s_mov_b32 s11, 0x20000
    s_mov_b32 s15, 0x20000
    s_lshr_b32 s69, s52, 1
    s_add_u32 s69, s69, 131072
    s_lshl_b32 s68, s47, 16
    s_add_u32 s68, s68, s56
    s_lshl_b32 s59, s46, 5
    s_add_u32 s68, s68, s59
    buffer_load_dwordx4 v11, s[4:7], s58 offen offset:3072 lds
    v_lshrrev_b32 v2, 4, v0
    v_and_b32 v29, 15, v0
    v_mul_u32_u24 v28, 3584, v2
    v_lshlrev_b32 v2, 28, v2
    v_lshl_add_u32 v28, v29, 3, v28
    v_lshl_add_u32 v2, v0, 3, v2
    s_lshl_b32 s35, s42, 17
    s_add_u32 s35, s35, s46
    s_add_u32 m0, s52, 32768
    s_add_u32 s58, s50, s30
    buffer_load_dwordx4 v8, s[4:7], s58 offen lds
    s_mul_i32 s35, s35, 28
    s_add_u32 s35, s35, s47
    s_lshl_b32 s35, s35, 7
    s_add_u32 s35, s35, 524288
    s_lshl_b32 s54, s44, 5
    s_add_u32 s54, s54, s43
    s_lshl_b32 s54, s54, 7
    s_add_u32 s54, s54, 32768
    buffer_load_dwordx4 v9, s[4:7], s58 offen offset:1024 lds
    s_cmp_eq_u32 s42, 0
    s_cselect_b32 s54, s54, 0x40000000
    s_add_u32 s59, s45, 3
    s_and_b32 s59, s59, 3
    v_and_b32 v30, 4, v0
    v_add_u32 v30, s59, v30
    v_add_u32 v26, 57, v30
    s_mul_i32 s59, s45, 7
    v_add_u32 v30, s59, v30
    s_lshr_b32 s59, s2, 3
    s_lshl_b32 s59, s59, 2
    s_add_u32 s59, s59, s42
    s_lshl_b32 s59, s59, 2
    v_and_b32 v31, 2, v0
    v_add_u32 v31, s59, v31
    v_bfe_u32 v27, v0, 3, 1
    v_add_u32 v31, v31, v27
    v_mul_u32_u24 v31, 3584, v31
    v_lshl_add_u32 v31, v30, 7, v31
    v_and_b32 v27, 1, v0
    v_lshl_add_u32 v31, v27, 6, v31
    v_lshrrev_b32 v26, 6, v26
    v_lshrrev_b32 v27, 4, v0
    v_or_b32 v26, v26, v27
    v_lshl_add_u32 v31, v26, 24, v31
    v_and_b32 v128, 3, v0
    v_bfe_u32 v129, v0, 3, 2
    v_lshl_add_u32 v128, v129, 2, v128
    v_bfe_u32 v129, v0, 2, 1
    v_lshl_add_u32 v128, v129, 4, v128
    s_lshr_b32 s61, s44, 1
    s_lshl_b32 s61, s61, 6
    s_and_b32 s60, s44, 1
    s_add_u32 s60, s60, s61
    v_lshl_add_u32 v128, v128, 1, s60
    v_cvt_f32_u32 v129, s48
    v_mul_f32 v129, 0xbe800000, v129
    s_lshl_b32 s61, s48, 8
    v_mov_b32 v130, s61
    v_cmp_eq_u32 vcc, 0, v128
    v_lshrrev_b32 v131, 5, v0
    s_lshl_b32 s61, s57, 7
    v_cndmask_b32 v128, v128, v130, vcc
    v_cndmask_b32 v129, v129, 0, vcc
    v_cvt_f32_u32 v128, v128
    v_mul_f32 v128, 0x3b000000, v128
    v_lshl_add_u32 v131, v131, 3, s61
    v_cvt_f32_u32 v131, v131
    v_fmac_f32 v129, v131, v128
    v_mul_f32 v130, 0x41800000, v128
    v_mov_b32 v132, v129
    v_add_f32 v140, v130, v129
    v_cos_f32 v130, v130
    v_add_f32 v133, v128, v132
    v_add_f32 v141, v128, v140
    v_add_f32 v134, v128, v133
    v_add_f32 v142, v128, v141
    v_add_f32 v135, v128, v134
    v_add_f32 v143, v128, v142
    v_add_f32 v136, v128, v135
    v_add_f32 v144, v128, v143
    v_add_f32 v137, v128, v136
    v_add_f32 v145, v128, v144
    v_add_f32 v138, v128, v137
    v_add_f32 v146, v128, v145
    v_add_f32 v139, v128, v138
    v_add_f32 v147, v128, v146
    v_add_f32 v130, v130, v130
    v_mov_b32 v131, v130
    v_cos_f32 v132, v132
    v_cos_f32 v133, v133
    v_cos_f32 v134, v134
    v_cos_f32 v135, v135
    v_cos_f32 v136, v136
    v_cos_f32 v137, v137
    v_cos_f32 v138, v138
    v_cos_f32 v139, v139
    v_cos_f32 v140, v140
    v_cos_f32 v141, v141
    v_cos_f32 v142, v142
    v_cos_f32 v143, v143
    v_cos_f32 v144, v144
    v_cos_f32 v145, v145
    v_cos_f32 v146, v146
    v_cos_f32 v147, v147
    v_cvt_pk_bf16_f32 v64, v132, v133
    v_cvt_pk_bf16_f32 v65, v134, v135
    v_cvt_pk_bf16_f32 v66, v136, v137
    v_cvt_pk_bf16_f32 v67, v138, v139
    v_cvt_pk_bf16_f32 v68, v140, v141
    v_cvt_pk_bf16_f32 v69, v142, v143
    v_cvt_pk_bf16_f32 v70, v144, v145
    v_cvt_pk_bf16_f32 v71, v146, v147
    v_pk_fma_f32 v[132:133], v[130:131], v[140:141], v[132:133] neg_lo:[0,0,1] neg_hi:[0,0,1]
    v_pk_fma_f32 v[134:135], v[130:131], v[142:143], v[134:135] neg_lo:[0,0,1] neg_hi:[0,0,1]
    v_pk_fma_f32 v[136:137], v[130:131], v[144:145], v[136:137] neg_lo:[0,0,1] neg_hi:[0,0,1]
    v_pk_fma_f32 v[138:139], v[130:131], v[146:147], v[138:139] neg_lo:[0,0,1] neg_hi:[0,0,1]
    v_cvt_pk_bf16_f32 v72, v132, v133
    v_cvt_pk_bf16_f32 v73, v134, v135
    v_cvt_pk_bf16_f32 v74, v136, v137
    v_cvt_pk_bf16_f32 v75, v138, v139
    v_pk_fma_f32 v[140:141], v[130:131], v[132:133], v[140:141] neg_lo:[0,0,1] neg_hi:[0,0,1]
    v_pk_fma_f32 v[142:143], v[130:131], v[134:135], v[142:143] neg_lo:[0,0,1] neg_hi:[0,0,1]
    v_pk_fma_f32 v[144:145], v[130:131], v[136:137], v[144:145] neg_lo:[0,0,1] neg_hi:[0,0,1]
    v_pk_fma_f32 v[146:147], v[130:131], v[138:139], v[146:147] neg_lo:[0,0,1] neg_hi:[0,0,1]
    v_cvt_pk_bf16_f32 v76, v140, v141
    v_cvt_pk_bf16_f32 v77, v142, v143
    v_cvt_pk_bf16_f32 v78, v144, v145
    v_cvt_pk_bf16_f32 v79, v146, v147
    v_pk_fma_f32 v[132:133], v[130:131], v[140:141], v[132:133] neg_lo:[0,0,1] neg_hi:[0,0,1]
    v_pk_fma_f32 v[134:135], v[130:131], v[142:143], v[134:135] neg_lo:[0,0,1] neg_hi:[0,0,1]
    v_pk_fma_f32 v[136:137], v[130:131], v[144:145], v[136:137] neg_lo:[0,0,1] neg_hi:[0,0,1]
    v_pk_fma_f32 v[138:139], v[130:131], v[146:147], v[138:139] neg_lo:[0,0,1] neg_hi:[0,0,1]
    v_cvt_pk_bf16_f32 v80, v132, v133
    v_cvt_pk_bf16_f32 v81, v134, v135
    v_cvt_pk_bf16_f32 v82, v136, v137
    v_cvt_pk_bf16_f32 v83, v138, v139
    v_pk_fma_f32 v[140:141], v[130:131], v[132:133], v[140:141] neg_lo:[0,0,1] neg_hi:[0,0,1]
    v_pk_fma_f32 v[142:143], v[130:131], v[134:135], v[142:143] neg_lo:[0,0,1] neg_hi:[0,0,1]
    v_pk_fma_f32 v[144:145], v[130:131], v[136:137], v[144:145] neg_lo:[0,0,1] neg_hi:[0,0,1]
    v_pk_fma_f32 v[146:147], v[130:131], v[138:139], v[146:147] neg_lo:[0,0,1] neg_hi:[0,0,1]
    v_cvt_pk_bf16_f32 v84, v140, v141
    v_cvt_pk_bf16_f32 v85, v142, v143
    v_cvt_pk_bf16_f32 v86, v144, v145
    v_cvt_pk_bf16_f32 v87, v146, v147
    v_pk_fma_f32 v[132:133], v[130:131], v[140:141], v[132:133] neg_lo:[0,0,1] neg_hi:[0,0,1]
    v_pk_fma_f32 v[134:135], v[130:131], v[142:143], v[134:135] neg_lo:[0,0,1] neg_hi:[0,0,1]
    v_pk_fma_f32 v[136:137], v[130:131], v[144:145], v[136:137] neg_lo:[0,0,1] neg_hi:[0,0,1]
    v_pk_fma_f32 v[138:139], v[130:131], v[146:147], v[138:139] neg_lo:[0,0,1] neg_hi:[0,0,1]
    v_cvt_pk_bf16_f32 v88, v132, v133
    v_cvt_pk_bf16_f32 v89, v134, v135
    v_cvt_pk_bf16_f32 v90, v136, v137
    v_cvt_pk_bf16_f32 v91, v138, v139
    v_pk_fma_f32 v[140:141], v[130:131], v[132:133], v[140:141] neg_lo:[0,0,1] neg_hi:[0,0,1]
    v_pk_fma_f32 v[142:143], v[130:131], v[134:135], v[142:143] neg_lo:[0,0,1] neg_hi:[0,0,1]
    v_pk_fma_f32 v[144:145], v[130:131], v[136:137], v[144:145] neg_lo:[0,0,1] neg_hi:[0,0,1]
    v_pk_fma_f32 v[146:147], v[130:131], v[138:139], v[146:147] neg_lo:[0,0,1] neg_hi:[0,0,1]
    v_cvt_pk_bf16_f32 v92, v140, v141
    v_cvt_pk_bf16_f32 v93, v142, v143
    v_cvt_pk_bf16_f32 v94, v144, v145
    v_cvt_pk_bf16_f32 v95, v146, v147
    v_pk_fma_f32 v[132:133], v[130:131], v[140:141], v[132:133] neg_lo:[0,0,1] neg_hi:[0,0,1]
    v_pk_fma_f32 v[134:135], v[130:131], v[142:143], v[134:135] neg_lo:[0,0,1] neg_hi:[0,0,1]
    v_pk_fma_f32 v[136:137], v[130:131], v[144:145], v[136:137] neg_lo:[0,0,1] neg_hi:[0,0,1]
    v_pk_fma_f32 v[138:139], v[130:131], v[146:147], v[138:139] neg_lo:[0,0,1] neg_hi:[0,0,1]
    v_cvt_pk_bf16_f32 v96, v132, v133
    v_cvt_pk_bf16_f32 v97, v134, v135
    v_cvt_pk_bf16_f32 v98, v136, v137
    v_cvt_pk_bf16_f32 v99, v138, v139
    v_pk_fma_f32 v[140:141], v[130:131], v[132:133], v[140:141] neg_lo:[0,0,1] neg_hi:[0,0,1]
    v_pk_fma_f32 v[142:143], v[130:131], v[134:135], v[142:143] neg_lo:[0,0,1] neg_hi:[0,0,1]
    v_pk_fma_f32 v[144:145], v[130:131], v[136:137], v[144:145] neg_lo:[0,0,1] neg_hi:[0,0,1]
    v_pk_fma_f32 v[146:147], v[130:131], v[138:139], v[146:147] neg_lo:[0,0,1] neg_hi:[0,0,1]
    v_cvt_pk_bf16_f32 v100, v140, v141
    v_cvt_pk_bf16_f32 v101, v142, v143
    v_cvt_pk_bf16_f32 v102, v144, v145
    v_cvt_pk_bf16_f32 v103, v146, v147
    v_pk_fma_f32 v[132:133], v[130:131], v[140:141], v[132:133] neg_lo:[0,0,1] neg_hi:[0,0,1]
    v_pk_fma_f32 v[134:135], v[130:131], v[142:143], v[134:135] neg_lo:[0,0,1] neg_hi:[0,0,1]
    v_pk_fma_f32 v[136:137], v[130:131], v[144:145], v[136:137] neg_lo:[0,0,1] neg_hi:[0,0,1]
    v_pk_fma_f32 v[138:139], v[130:131], v[146:147], v[138:139] neg_lo:[0,0,1] neg_hi:[0,0,1]
    v_cvt_pk_bf16_f32 v104, v132, v133
    v_cvt_pk_bf16_f32 v105, v134, v135
    v_cvt_pk_bf16_f32 v106, v136, v137
    v_cvt_pk_bf16_f32 v107, v138, v139
    v_pk_fma_f32 v[140:141], v[130:131], v[132:133], v[140:141] neg_lo:[0,0,1] neg_hi:[0,0,1]
    v_pk_fma_f32 v[142:143], v[130:131], v[134:135], v[142:143] neg_lo:[0,0,1] neg_hi:[0,0,1]
    v_pk_fma_f32 v[144:145], v[130:131], v[136:137], v[144:145] neg_lo:[0,0,1] neg_hi:[0,0,1]
    v_pk_fma_f32 v[146:147], v[130:131], v[138:139], v[146:147] neg_lo:[0,0,1] neg_hi:[0,0,1]
    v_cvt_pk_bf16_f32 v108, v140, v141
    v_cvt_pk_bf16_f32 v109, v142, v143
    v_cvt_pk_bf16_f32 v110, v144, v145
    v_cvt_pk_bf16_f32 v111, v146, v147
    v_pk_fma_f32 v[132:133], v[130:131], v[140:141], v[132:133] neg_lo:[0,0,1] neg_hi:[0,0,1]
    v_pk_fma_f32 v[134:135], v[130:131], v[142:143], v[134:135] neg_lo:[0,0,1] neg_hi:[0,0,1]
    s_cmp_eq_u32 s42, 0
    s_cbranch_scc1 L_wA_m1
    s_cmp_eq_u32 s42, 1
    s_cbranch_scc1 L_wA_m2
    s_cmp_eq_u32 s42, 2
    s_cbranch_scc1 L_wA_m3
    s_cmp_eq_u32 s42, 3
    s_cbranch_scc1 L_wA_m4
L_retA:
    buffer_load_dwordx4 v10, s[4:7], s58 offen offset:2048 lds
    v_pk_fma_f32 v[136:137], v[130:131], v[144:145], v[136:137] neg_lo:[0,0,1] neg_hi:[0,0,1]
    v_pk_fma_f32 v[138:139], v[130:131], v[146:147], v[138:139] neg_lo:[0,0,1] neg_hi:[0,0,1]
    v_cvt_pk_bf16_f32 v112, v132, v133
    v_cvt_pk_bf16_f32 v113, v134, v135
    v_cvt_pk_bf16_f32 v114, v136, v137
    v_cvt_pk_bf16_f32 v115, v138, v139
    v_pk_fma_f32 v[140:141], v[130:131], v[132:133], v[140:141] neg_lo:[0,0,1] neg_hi:[0,0,1]
    v_pk_fma_f32 v[142:143], v[130:131], v[134:135], v[142:143] neg_lo:[0,0,1] neg_hi:[0,0,1]
    buffer_load_dwordx4 v11, s[4:7], s58 offen offset:3072 lds
    v_pk_fma_f32 v[144:145], v[130:131], v[136:137], v[144:145] neg_lo:[0,0,1] neg_hi:[0,0,1]
    v_pk_fma_f32 v[146:147], v[130:131], v[138:139], v[146:147] neg_lo:[0,0,1] neg_hi:[0,0,1]
    v_cvt_pk_bf16_f32 v116, v140, v141
    v_cvt_pk_bf16_f32 v117, v142, v143
    v_cvt_pk_bf16_f32 v118, v144, v145
    v_cvt_pk_bf16_f32 v119, v146, v147
    v_pk_fma_f32 v[132:133], v[130:131], v[140:141], v[132:133] neg_lo:[0,0,1] neg_hi:[0,0,1]
    v_pk_fma_f32 v[134:135], v[130:131], v[142:143], v[134:135] neg_lo:[0,0,1] neg_hi:[0,0,1]
    s_add_u32 m0, s52, 49152
    s_add_u32 s58, s50, s31
    buffer_load_dwordx4 v8, s[4:7], s58 offen lds
    v_pk_fma_f32 v[136:137], v[130:131], v[144:145], v[136:137] neg_lo:[0,0,1] neg_hi:[0,0,1]
    v_pk_fma_f32 v[138:139], v[130:131], v[146:147], v[138:139] neg_lo:[0,0,1] neg_hi:[0,0,1]
    v_cvt_pk_bf16_f32 v120, v132, v133
    v_cvt_pk_bf16_f32 v121, v134, v135
    v_cvt_pk_bf16_f32 v122, v136, v137
    v_cvt_pk_bf16_f32 v123, v138, v139
    v_pk_fma_f32 v[140:141], v[130:131], v[132:133], v[140:141] neg_lo:[0,0,1] neg_hi:[0,0,1]
    v_pk_fma_f32 v[142:143], v[130:131], v[134:135], v[142:143] neg_lo:[0,0,1] neg_hi:[0,0,1]
    buffer_load_dwordx4 v9, s[4:7], s58 offen offset:1024 lds
    v_pk_fma_f32 v[144:145], v[130:131], v[136:137], v[144:145] neg_lo:[0,0,1] neg_hi:[0,0,1]
    v_pk_fma_f32 v[146:147], v[130:131], v[138:139], v[146:147] neg_lo:[0,0,1] neg_hi:[0,0,1]
    v_cvt_pk_bf16_f32 v124, v140, v141
    v_cvt_pk_bf16_f32 v125, v142, v143
    v_cvt_pk_bf16_f32 v126, v144, v145
    v_cvt_pk_bf16_f32 v127, v146, v147
    v_and_b32 v128, 15, v0
    v_and_b32 v130, 31, v0
    buffer_load_dwordx4 v10, s[4:7], s58 offen offset:2048 lds
    s_lshl_b32 s60, s49, 13
    v_lshl_add_u32 v130, v130, 8, s60
    v_lshrrev_b32 v131, 5, v0
    v_xor_b32 v131, v131, v128
    v_lshl_add_u32 v12, v131, 4, v130
    v_xor_b32 v13, 32, v12
    v_xor_b32 v14, 64, v12
    v_xor_b32 v15, 96, v12
    buffer_load_dwordx4 v11, s[4:7], s58 offen offset:3072 lds
    v_xor_b32 v16, 128, v12
    v_xor_b32 v17, 160, v12
    v_xor_b32 v18, 192, v12
    v_xor_b32 v19, 224, v12
    v_and_b32 v128, 15, v0
    s_lshl_b32 s59, s42, 4
    v_add_u32 v128, s59, v128
    v_and_b32 v131, 1, v0
    s_mov_b32 m0, s69
    s_add_u32 s58, s68, 7168
    buffer_load_dwordx4 v5, s[64:67], s68 offen nt lds
    v_lshrrev_b32 v129, 1, v128
    v_cvt_f32_u32 v131, v131
    v_cvt_f32_u32 v129, v129
    v_cmp_eq_u32 vcc, 1, v128
    v_mul_f32 v131, 0xbe800000, v131
    v_mul_f32 v129, 0x3c800000, v129
    v_and_b32 v130, 48, v0
    v_cndmask_b32 v131, v131, 0, vcc
    buffer_load_dwordx4 v5, s[64:67], s58 offen offset:1024 nt lds
    v_cndmask_b32 v129, v129, 0.5, vcc
    v_cvt_f32_u32 v132, v130
    v_mul_u32_u24 v128, 136, v128
    v_fmac_f32 v131, v132, v129
    v_lshl_add_u32 v130, v130, 1, v128
    v_add_u32 v130, 147456, v130
    v_fmamk_f32 v132, v129, 0x00000000, v131
    v_fmamk_f32 v133, v129, 0x3f800000, v131
    buffer_load_dword a220, v31, s[8:11], 0 offen
    v_fmamk_f32 v134, v129, 0x40000000, v131
    v_fmamk_f32 v135, v129, 0x40400000, v131
    v_fmamk_f32 v136, v129, 0x40800000, v131
    v_fmamk_f32 v137, v129, 0x40a00000, v131
    v_fmamk_f32 v138, v129, 0x40c00000, v131
    v_fmamk_f32 v139, v129, 0x40e00000, v131
    v_cos_f32 v132, v132
    v_cos_f32 v133, v133
    buffer_load_dword a221, v31, s[12:15], 0 offen offset:1024
    v_cos_f32 v134, v134
    v_cos_f32 v135, v135
    v_cos_f32 v136, v136
    v_cos_f32 v137, v137
    v_cos_f32 v138, v138
    v_cos_f32 v139, v139
    v_cvt_pk_bf16_f32 v132, v132, v133
    v_cvt_pk_bf16_f32 v133, v134, v135
    buffer_store_dwordx2 v[0:1], v28, s[20:23], s35 offen sc1
    v_cvt_pk_bf16_f32 v134, v136, v137
    v_cvt_pk_bf16_f32 v135, v138, v139
    ds_write2_b64 v130, v[132:133], v[134:135] offset0:0 offset1:1
    v_fmamk_f32 v132, v129, 0x41000000, v131
    v_fmamk_f32 v133, v129, 0x41100000, v131
    v_fmamk_f32 v134, v129, 0x41200000, v131
    v_fmamk_f32 v135, v129, 0x41300000, v131
    v_fmamk_f32 v136, v129, 0x41400000, v131
    buffer_store_dwordx2 v[0:1], v2, s[20:23], s54 offen sc1
    v_fmamk_f32 v137, v129, 0x41500000, v131
    v_fmamk_f32 v138, v129, 0x41600000, v131
    v_fmamk_f32 v139, v129, 0x41700000, v131
    v_cos_f32 v132, v132
    v_cos_f32 v133, v133
    v_cos_f32 v134, v134
    v_cos_f32 v135, v135
    v_cos_f32 v136, v136
    s_mul_i32 s58, s28, 1792
    s_add_u32 m0, s52, 65536
    s_add_u32 s58, s58, s51
    buffer_load_dwordx4 v20, s[8:11], s58 offen lds
    v_cos_f32 v137, v137
    v_cos_f32 v138, v138
    v_cos_f32 v139, v139
    v_cvt_pk_bf16_f32 v132, v132, v133
    v_cvt_pk_bf16_f32 v133, v134, v135
    v_cvt_pk_bf16_f32 v134, v136, v137
    v_cvt_pk_bf16_f32 v135, v138, v139
    ds_write2_b64 v130, v[132:133], v[134:135] offset0:2 offset1:3
    s_waitcnt vmcnt(15) lgkmcnt(0)
    s_barrier
    ds_read_b128 v[128:131], v12 offset:0
    ds_read_b128 v[132:135], v13 offset:0
    ds_read_b128 v[136:139], v14 offset:0
    ds_read_b128 v[140:143], v15 offset:0
    ds_read_b128 v[144:147], v16 offset:0
    ds_read_b128 v[148:151], v17 offset:0
    s_waitcnt lgkmcnt(5)
    v_mfma_f32_32x32x16_bf16 v[32:47], v[128:131], v[64:67], 0
    ds_read_b128 v[152:155], v18 offset:0
    ds_read_b128 v[156:159], v19 offset:0
    buffer_load_dwordx4 v21, s[12:15], s58 offen offset:1024 lds
    v_lshrrev_b32 v60, 4, v0
    s_waitcnt lgkmcnt(6)
    v_mfma_f32_32x32x16_bf16 v[32:47], v[132:135], v[68:71], v[32:47]
    s_branch L_ld_m1
.p2align 12
L_st_m1:
L_wA_m1:
    s_branch L_retA
L_ld_m1:
    ds_read_b128 v[160:163], v12 offset:16384
    ds_read_b128 v[164:167], v13 offset:16384
    v_bfe_u32 v61, v0, 2, 2
    v_and_b32 v62, 3, v0
    v_bfe_u32 v63, v0, 3, 2
    s_waitcnt lgkmcnt(7)
    v_mfma_f32_32x32x16_bf16 v[32:47], v[136:139], v[72:75], v[32:47]
    ds_read_b128 v[168:171], v14 offset:16384
    ds_read_b128 v[172:175], v15 offset:16384
    buffer_load_dwordx4 v22, s[8:11], s58 offen offset:2048 lds
    s_waitcnt lgkmcnt(6)
    v_mfma_f32_32x32x16_bf16 v[32:47], v[140:143], v[76:79], v[32:47]
    ds_read_b128 v[176:179], v16 offset:16384
    ds_read_b128 v[180:183], v17 offset:16384
    s_lshl_b32 s59, s48, 1
    v_lshlrev_b32 v62, 3, v62
    v_xor_b32 v63, s59, v63
    v_lshl_add_u32 v62, v61, 7, v62
    v_mfma_f32_32x32x16_bf16 v[32:47], v[144:147], v[80:83], v[32:47]
    ds_read_b128 v[184:187], v18 offset:16384
    ds_read_b128 v[188:191], v19 offset:16384
    s_lshl_b32 s55, s46, 1
    s_and_b32 s55, s55, 24
    s_add_u32 s55, s55, s42
    v_lshl_add_u32 v27, v60, 10, v62
    v_mfma_f32_32x32x16_bf16 v[32:47], v[148:151], v[84:87], v[32:47]
    buffer_load_dwordx4 v23, s[12:15], s58 offen offset:3072 lds
    s_mul_i32 s55, s55, 28
    v_lshrrev_b32 v60, 5, v0
    v_lshl_add_u32 v27, v63, 5, v27
    v_bfe_u32 v61, v0, 4, 1
    s_waitcnt lgkmcnt(4)
    v_mfma_f32_32x32x16_bf16 v[32:47], v[152:155], v[88:91], v[32:47]
    s_mul_i32 s58, s28, 1792
    s_add_u32 m0, s52, 81920
    s_add_u32 s58, s58, s38
    s_add_u32 s55, s55, s47
    v_add_u32 v24, 65536, v27
    v_lshl_add_u32 v62, v60, 9, v62
    v_mfma_f32_32x32x16_bf16 v[32:47], v[156:159], v[92:95], v[32:47]
    s_waitcnt vmcnt(10)
    s_barrier
    v_mfma_f32_32x32x16_bf16 v[32:47], v[160:163], v[96:99], v[32:47]
    ds_read_b128 v[192:195], v12 offset:32768
    ds_read_b128 v[196:199], v13 offset:32768
    buffer_load_dwordx4 v20, s[8:11], s58 offen lds
    v_lshrrev_b32 v2, 4, v0
    v_mfma_f32_32x32x16_bf16 v[32:47], v[164:167], v[100:103], v[32:47]
    ds_read_b128 v[200:203], v14 offset:32768
    ds_read_b128 v[204:207], v15 offset:32768
    s_lshl_b32 s55, s55, 1
    v_lshlrev_b32 v2, 28, v2
    v_lshl_add_u32 v2, v0, 3, v2
    v_and_b32 v31, 31, v0
    v_mfma_f32_32x32x16_bf16 v[32:47], v[168:171], v[104:107], v[32:47]
    ds_read_b128 v[208:211], v16 offset:32768
    ds_read_b128 v[212:215], v17 offset:32768
    buffer_load_dwordx4 v21, s[12:15], s58 offen offset:1024 lds
    v_bfe_u32 v63, v0, 3, 1
    v_mfma_f32_32x32x16_bf16 v[32:47], v[172:175], v[108:111], v[32:47]
    ds_read_b128 v[216:219], v18 offset:32768
    ds_read_b128 v[220:223], v19 offset:32768
    s_lshr_b32 s59, s46, 4
    s_add_u32 s55, s55, s59
    v_xor_b32 v25, 32, v24
    v_mul_u32_u24 v28, 136, v31
    s_waitcnt lgkmcnt(6)
    v_mfma_f32_32x32x16_bf16 v[32:47], v[176:179], v[112:115], v[32:47]
    ds_read_b128 v[224:227], v12 offset:49152
    buffer_load_dwordx4 v22, s[8:11], s58 offen offset:2048 lds
    v_lshl_add_u32 v62, v61, 5, v62
    v_lshl_add_u32 v62, v63, 6, v62
    v_mfma_f32_32x32x16_bf16 v[32:47], v[180:183], v[116:119], v[32:47]
    ds_read_b128 v[228:231], v13 offset:49152
    ds_read_b128 v[232:235], v14 offset:49152
    s_lshl_b32 s55, s55, 10
    s_add_u32 s55, s55, 12582912
    v_add_u32 v26, s69, v62
    v_xor_b32 v27, 64, v26
    v_mfma_f32_32x32x16_bf16 v[32:47], v[184:187], v[120:123], v[32:47]
    ds_read_b128 v[236:239], v15 offset:49152
    ds_read_b128 v[240:243], v16 offset:49152
    buffer_load_dwordx4 v23, s[12:15], s58 offen offset:3072 lds
    s_add_u32 s53, s55, 229376
    v_mfma_f32_32x32x16_bf16 v[32:47], v[188:191], v[124:127], v[32:47]
    ds_read_b128 v[244:247], v17 offset:49152
    ds_read_b128 v[248:251], v18 offset:49152
    v_mfma_f32_32x32x16_bf16 v[48:63], v[192:195], v[64:67], 0
    ds_read_b128 v[252:255], v19 offset:49152
    s_waitcnt vmcnt(12)
    ds_read_b64_tr_b16 a[248:249], v26 offset:0
    ds_read_b64_tr_b16 a[250:251], v26 offset:1024
    ds_read_b64_tr_b16 a[252:253], v27 offset:0
    ds_read_b64_tr_b16 a[254:255], v27 offset:1024
    v_mfma_f32_32x32x16_bf16 v[48:63], v[196:199], v[68:71], v[48:63]
    s_mul_i32 s58, s29, 1792
    s_add_u32 m0, s52, 98304
    s_add_u32 s58, s58, s51
    buffer_load_dwordx4 v20, s[8:11], s58 offen lds
    s_waitcnt lgkmcnt(7)
    v_mfma_f32_32x32x16_bf16 v[48:63], v[200:203], v[72:75], v[48:63]
    s_xor_b32 s59, s42, 1
    s_lshl_b32 s59, s59, 11
    s_add_u32 s59, s59, 139264
    v_lshl_add_u32 v30, v31, 6, s59
    v_add_u32 v4, s59, v1
    v_xor_b32 v3, 2048, v4
    v_mfma_f32_32x32x16_bf16 v[48:63], v[204:207], v[76:79], v[48:63]
    s_waitcnt lgkmcnt(4)
    s_barrier
    v_mfma_f32_32x32x16_bf16 v[48:63], v[208:211], v[80:83], v[48:63]
    s_waitcnt lgkmcnt(0)
    buffer_store_dwordx4 a[248:251], v1, s[20:23], s55 offen sc1
    buffer_load_dwordx4 v21, s[12:15], s58 offen offset:1024 lds
    v_lshrrev_b32 v31, 5, v0
    v_mfma_f32_32x32x16_bf16 v[48:63], v[212:215], v[84:87], v[48:63]
    v_lshl_add_u32 v28, v31, 3, v28
    v_lshl_add_u32 v30, v31, 5, v30
    s_mul_i32 s59, s49, 4288
    s_add_u32 s59, s59, 147520
    v_add_u32 v29, s59, v28
    v_mfma_f32_32x32x16_bf16 v[48:63], v[216:219], v[88:91], v[48:63]
    buffer_store_dwordx4 a[252:255], v1, s[20:23], s53 offen sc1
    buffer_load_dwordx4 v22, s[8:11], s58 offen offset:2048 lds
    v_mfma_f32_32x32x16_bf16 v[48:63], v[220:223], v[92:95], v[48:63]
    s_mul_i32 s59, s49, 4416
    s_add_u32 s59, s59, 147456
    v_add_u32 v28, s59, v28
    v_bfe_u32 v31, v0, 1, 2
    v_lshlrev_b32 v31, 4, v31
    v_xor_b32 v30, v31, v30
    v_mfma_f32_32x32x16_bf16 v[48:63], v[224:227], v[96:99], v[48:63]
    buffer_load_dwordx4 v23, s[12:15], s58 offen offset:3072 lds
    v_xor_b32 v31, 16, v30
    v_mfma_f32_32x32x16_bf16 v[48:63], v[228:231], v[100:103], v[48:63]
    s_mul_i32 s58, s29, 1792
    s_add_u32 m0, s52, 114688
    s_add_u32 s58, s58, s38
    s_and_b32 s61, s44, 1
    s_lshl_b32 s61, s61, 31
    s_or_b32 s61, s61, 0x3f800000
    v_mfma_f32_32x32x16_bf16 v[48:63], v[232:235], v[104:107], v[48:63]
    s_lshl_b32 s60, s43, 3
    s_add_u32 s60, s60, s44
    s_lshl_b32 s60, s60, 2
    s_add_u32 s60, s60, s42
    s_lshl_b32 s60, s60, 11
    s_add_u32 s60, s60, 1048576
    v_mfma_f32_32x32x16_bf16 v[48:63], v[236:239], v[108:111], v[48:63]
    buffer_load_dwordx4 v20, s[8:11], s58 offen lds
    v_mfma_f32_32x32x16_bf16 v[48:63], v[240:243], v[112:115], v[48:63]
    ds_read2_b64 a[232:235], v28 offset0:0 offset1:2
    v_mfma_f32_32x32x16_bf16 v[48:63], v[244:247], v[116:119], v[48:63]
    ds_read2_b64 a[236:239], v28 offset0:4 offset1:6
    buffer_load_dwordx4 v21, s[12:15], s58 offen offset:1024 lds
    v_mfma_f32_32x32x16_bf16 v[48:63], v[248:251], v[120:123], v[48:63]
    ds_read2_b64 a[240:243], v29 offset0:0 offset1:2
    v_mfma_f32_32x32x16_bf16 v[48:63], v[252:255], v[124:127], v[48:63]
    ds_read2_b64 a[244:247], v29 offset0:4 offset1:6
    buffer_load_dwordx4 v22, s[8:11], s58 offen offset:2048 lds
    s_mov_b32 s16, s45
    s_add_u32 s17, s45, 1
    s_and_b32 s17, s17, 3
    s_add_u32 s18, s45, 2
    s_and_b32 s18, s18, 3
    s_add_u32 s19, s45, 3
    s_and_b32 s19, s19, 3
    s_nop 2
    v_pk_fma_f32 v[32:33], v[48:49], s[60:61], v[32:33] op_sel:[0,1,0] op_sel_hi:[1,1,1]
    v_pk_fma_f32 v[34:35], v[50:51], s[60:61], v[34:35] op_sel:[0,1,0] op_sel_hi:[1,1,1]
    v_pk_fma_f32 v[36:37], v[52:53], s[60:61], v[36:37] op_sel:[0,1,0] op_sel_hi:[1,1,1]
    v_pk_fma_f32 v[38:39], v[54:55], s[60:61], v[38:39] op_sel:[0,1,0] op_sel_hi:[1,1,1]
    v_cvt_pk_bf16_f32 v96, v32, v33
    v_cvt_pk_bf16_f32 v97, v34, v35
    v_cvt_pk_bf16_f32 v98, v36, v37
    v_cvt_pk_bf16_f32 v99, v38, v39
    ds_write_b128 v3, v[96:99] offset:0
    v_pk_fma_f32 v[40:41], v[56:57], s[60:61], v[40:41] op_sel:[0,1,0] op_sel_hi:[1,1,1]
    v_pk_fma_f32 v[42:43], v[58:59], s[60:61], v[42:43] op_sel:[0,1,0] op_sel_hi:[1,1,1]
    v_pk_fma_f32 v[44:45], v[60:61], s[60:61], v[44:45] op_sel:[0,1,0] op_sel_hi:[1,1,1]
    v_pk_fma_f32 v[46:47], v[62:63], s[60:61], v[46:47] op_sel:[0,1,0] op_sel_hi:[1,1,1]
    v_cvt_pk_bf16_f32 v100, v40, v41
    v_cvt_pk_bf16_f32 v101, v42, v43
    v_cvt_pk_bf16_f32 v102, v44, v45
    v_cvt_pk_bf16_f32 v103, v46, v47
    ds_write_b128 v3, v[100:103] offset:1024
    s_waitcnt lgkmcnt(5)
    v_mfma_f32_32x32x16_bf16 v[32:47], v[96:99], a[232:235], 0
    s_waitcnt lgkmcnt(4)
    v_mfma_f32_32x32x16_bf16 v[32:47], v[100:103], a[236:239], v[32:47]
    buffer_load_dwordx4 v23, s[12:15], s58 offen offset:3072 lds
    s_waitcnt lgkmcnt(0)
    s_barrier
    ds_read_b128 v[104:107], v4 offset:0
    ds_read_b128 v[108:111], v4 offset:1024
    v_readfirstlane_b32 s40, v6
    v_readfirstlane_b32 s41, v7
    s_mul_i32 s40, s40, 0x9E3779B1
    s_add_u32 s40, s40, 0x7F4A7C15
    s_mul_i32 s41, s41, 0x85EBCA6D
    s_add_u32 s41, s41, 0xC2B2AE35
    v_mov_b32 v6, s40
    v_mov_b32 v7, s41
    s_mul_i32 s58, s30, 1792
    s_add_u32 m0, s52, 0
    s_add_u32 s58, s58, s51
    buffer_load_dwordx4 v20, s[8:11], s58 offen lds
    s_waitcnt lgkmcnt(1)
    v_mfma_f32_32x32x16_bf16 v[32:47], v[104:107], a[240:243], v[32:47]
    s_waitcnt lgkmcnt(0)
    v_mfma_f32_32x32x16_bf16 v[32:47], v[108:111], a[244:247], v[32:47]
    v_xor_b32 v12, 65536, v12
    v_xor_b32 v13, 65536, v13
    v_xor_b32 v14, 65536, v14
    v_xor_b32 v15, 65536, v15
    v_xor_b32 v16, 65536, v16
    v_xor_b32 v17, 65536, v17
    v_xor_b32 v18, 65536, v18
    v_xor_b32 v19, 65536, v19
    s_lshl_b32 s36, s42, 9
    s_add_u32 s36, s36, s46
    s_lshl_b32 s36, s36, 10
    buffer_load_dwordx4 v21, s[12:15], s58 offen offset:1024 lds
    buffer_load_dwordx4 v22, s[8:11], s58 offen offset:2048 lds
    v_cvt_pk_bf16_f32 v48, v32, v33
    v_cvt_pk_bf16_f32 v49, v34, v35
    v_cvt_pk_bf16_f32 v50, v36, v37
    v_cvt_pk_bf16_f32 v51, v38, v39
    ds_write_b128 v30, v[48:51]
    v_cvt_pk_bf16_f32 v52, v40, v41
    v_cvt_pk_bf16_f32 v53, v42, v43
    v_cvt_pk_bf16_f32 v54, v44, v45
    v_cvt_pk_bf16_f32 v55, v46, v47
    ds_write_b128 v31, v[52:55]
    ds_read_b128 v[56:59], v4 offset:0
    ds_read_b128 v[60:63], v4 offset:1024
    buffer_load_dwordx4 v23, s[12:15], s58 offen offset:3072 lds
    s_mul_i32 s58, s30, 1792
    s_add_u32 m0, s52, 16384
    s_add_u32 s58, s58, s38
    buffer_load_dwordx4 v20, s[8:11], s58 offen lds
    s_waitcnt lgkmcnt(1)
    buffer_store_dwordx4 v[56:59], v1, s[20:23], s60 offen sc1
    s_waitcnt lgkmcnt(0)
    buffer_store_dwordx4 v[60:63], v1, s[20:23], s60 offen offset:1024 sc1
    s_cmp_eq_u32 s42, 0
    s_cbranch_scc1 L_wB_m5
L_retB:
    s_add_u32 s55, s54, 65536
    s_waitcnt vmcnt(13)
    s_barrier
    ds_read_b64_tr_b16 a[0:1], v24 offset:0
    ds_read_b64_tr_b16 a[2:3], v24 offset:512
    ds_read_b64_tr_b16 a[128:129], v25 offset:0
    ds_read_b64_tr_b16 a[130:131], v25 offset:512
    ds_read_b64_tr_b16 a[4:5], v24 offset:4096
    ds_read_b64_tr_b16 a[6:7], v24 offset:4608
    ds_read_b64_tr_b16 a[132:133], v25 offset:4096
    ds_read_b64_tr_b16 a[134:135], v25 offset:4608
    ds_read_b64_tr_b16 a[8:9], v24 offset:8192
    ds_read_b64_tr_b16 a[10:11], v24 offset:8704
    ds_read_b64_tr_b16 a[136:137], v25 offset:8192
    ds_read_b64_tr_b16 a[138:139], v25 offset:8704
    ds_read_b64_tr_b16 a[12:13], v24 offset:12288
    ds_read_b64_tr_b16 a[14:15], v24 offset:12800
    ds_read_b64_tr_b16 a[140:141], v25 offset:12288
    ds_read_b64_tr_b16 a[142:143], v25 offset:12800
    buffer_store_dwordx2 v[6:7], v2, s[20:23], s55 offen sc1
    buffer_load_dwordx4 v21, s[12:15], s58 offen offset:1024 lds
    buffer_load_dwordx4 v22, s[8:11], s58 offen offset:2048 lds
    buffer_load_dwordx4 v23, s[12:15], s58 offen offset:3072 lds
    s_mul_i32 s58, s31, 1792
    s_add_u32 m0, s52, 32768
    s_add_u32 s58, s58, s51
    buffer_load_dwordx4 v20, s[8:11], s58 offen lds
    s_waitcnt lgkmcnt(14)
    v_mfma_f32_32x32x16_bf16 v[64:79], a[0:3], v[128:131], 0
    ds_read_b64_tr_b16 a[16:17], v24 offset:16384
    ds_read_b64_tr_b16 a[18:19], v24 offset:16896
    ds_read_b64_tr_b16 a[144:145], v25 offset:16384
    ds_read_b64_tr_b16 a[146:147], v25 offset:16896
    s_waitcnt lgkmcnt(15)
    v_mfma_f32_32x32x16_bf16 v[80:95], a[128:131], v[128:131], 0
    ds_read_b64_tr_b16 a[20:21], v24 offset:20480
    ds_read_b64_tr_b16 a[22:23], v24 offset:20992
    ds_read_b64_tr_b16 a[148:149], v25 offset:20480
    ds_read_b64_tr_b16 a[150:151], v25 offset:20992
    s_waitcnt lgkmcnt(15)
    v_mfma_f32_32x32x16_bf16 v[64:79], a[4:7], v[132:135], v[64:79]
    ds_read_b64_tr_b16 a[24:25], v24 offset:24576
    ds_read_b64_tr_b16 a[26:27], v24 offset:25088
    ds_read_b64_tr_b16 a[152:153], v25 offset:24576
    ds_read_b64_tr_b16 a[154:155], v25 offset:25088
    v_mfma_f32_32x32x16_bf16 v[80:95], a[132:135], v[132:135], v[80:95]
    ds_read_b64_tr_b16 a[28:29], v24 offset:28672
    ds_read_b64_tr_b16 a[30:31], v24 offset:29184
    ds_read_b64_tr_b16 a[156:157], v25 offset:28672
    ds_read_b64_tr_b16 a[158:159], v25 offset:29184
    s_waitcnt lgkmcnt(12)
    v_mfma_f32_32x32x16_bf16 v[64:79], a[8:11], v[136:139], v[64:79]
    buffer_load_dwordx4 v21, s[12:15], s58 offen offset:1024 lds
    v_mfma_f32_32x32x16_bf16 v[80:95], a[136:139], v[136:139], v[80:95]
    v_mfma_f32_32x32x16_bf16 v[64:79], a[12:15], v[140:143], v[64:79]
    s_waitcnt vmcnt(6) lgkmcnt(0)
    s_barrier
    v_mfma_f32_32x32x16_bf16 v[80:95], a[140:143], v[140:143], v[80:95]
    ds_read_b64_tr_b16 a[32:33], v24 offset:32768
    ds_read_b64_tr_b16 a[34:35], v24 offset:33280
    ds_read_b64_tr_b16 a[160:161], v25 offset:32768
    buffer_store_dwordx2 v[6:7], v2, s[20:23], s54 offen sc1
    v_mfma_f32_32x32x16_bf16 v[64:79], a[16:19], v[144:147], v[64:79]
    ds_read_b64_tr_b16 a[162:163], v25 offset:33280
    ds_read_b64_tr_b16 a[36:37], v24 offset:36864
    ds_read_b64_tr_b16 a[38:39], v24 offset:37376
    ds_read_b64_tr_b16 a[164:165], v25 offset:36864
    s_add_u32 s64, s45, 0
    s_lshl_b32 s34, s46, 1
    v_mfma_f32_32x32x16_bf16 v[80:95], a[144:147], v[144:147], v[80:95]
    ds_read_b64_tr_b16 a[166:167], v25 offset:37376
    ds_read_b64_tr_b16 a[40:41], v24 offset:40960
    ds_read_b64_tr_b16 a[42:43], v24 offset:41472
    buffer_load_dwordx4 v22, s[8:11], s58 offen offset:2048 lds
    v_mfma_f32_32x32x16_bf16 v[64:79], a[20:23], v[148:151], v[64:79]
    ds_read_b64_tr_b16 a[168:169], v25 offset:40960
    ds_read_b64_tr_b16 a[170:171], v25 offset:41472
    ds_read_b64_tr_b16 a[44:45], v24 offset:45056
    ds_read_b64_tr_b16 a[46:47], v24 offset:45568
    s_and_b32 s64, s64, 3
    s_add_u32 s57, s46, s64
    v_mfma_f32_32x32x16_bf16 v[80:95], a[148:151], v[148:151], v[80:95]
    ds_read_b64_tr_b16 a[172:173], v25 offset:45056
    ds_read_b64_tr_b16 a[174:175], v25 offset:45568
    buffer_load_dwordx4 v23, s[12:15], s58 offen offset:3072 lds
    s_add_u32 s34, s34, s48
    v_mfma_f32_32x32x16_bf16 v[64:79], a[24:27], v[152:155], v[64:79]
    ds_read_b64_tr_b16 a[48:49], v24 offset:49152
    ds_read_b64_tr_b16 a[50:51], v24 offset:49664
    s_sub_u32 s65, s64, 1
    v_mfma_f32_32x32x16_bf16 v[80:95], a[152:155], v[152:155], v[80:95]
    ds_read_b64_tr_b16 a[176:177], v25 offset:49152
    ds_read_b64_tr_b16 a[178:179], v25 offset:49664
    s_mul_i32 s58, s31, 1792
    s_add_u32 m0, s52, 49152
    s_add_u32 s58, s58, s38
    s_and_b32 s65, s65, 3
    v_mfma_f32_32x32x16_bf16 v[64:79], a[28:31], v[156:159], v[64:79]
    ds_read_b64_tr_b16 a[52:53], v24 offset:53248
    ds_read_b64_tr_b16 a[54:55], v24 offset:53760
    buffer_load_dwordx4 v20, s[8:11], s58 offen lds
    s_sub_u32 s66, s64, 2
    v_mfma_f32_32x32x16_bf16 v[80:95], a[156:159], v[156:159], v[80:95]
    ds_read_b64_tr_b16 a[180:181], v25 offset:53248
    ds_read_b64_tr_b16 a[182:183], v25 offset:53760
    s_mul_i32 s34, s34, 56
    s_and_b32 s66, s66, 3
    s_waitcnt lgkmcnt(6)
    v_mfma_f32_32x32x16_bf16 v[64:79], a[32:35], v[160:163], v[64:79]
    ds_read_b64_tr_b16 a[56:57], v24 offset:57344
    ds_read_b64_tr_b16 a[58:59], v24 offset:57856
    buffer_load_dwordx4 v21, s[12:15], s58 offen offset:1024 lds
    v_mfma_f32_32x32x16_bf16 v[80:95], a[160:163], v[160:163], v[80:95]
    ds_read_b64_tr_b16 a[184:185], v25 offset:57344
    ds_read_b64_tr_b16 a[186:187], v25 offset:57856
    s_sub_u32 s67, s64, 3
    v_mfma_f32_32x32x16_bf16 v[64:79], a[36:39], v[164:167], v[64:79]
    ds_read_b64_tr_b16 a[60:61], v24 offset:61440
    ds_read_b64_tr_b16 a[62:63], v24 offset:61952
    s_add_u32 s34, s34, s47
    s_and_b32 s67, s67, 3
    v_mfma_f32_32x32x16_bf16 v[80:95], a[164:167], v[164:167], v[80:95]
    ds_read_b64_tr_b16 a[188:189], v25 offset:61440
    ds_read_b64_tr_b16 a[190:191], v25 offset:61952
    buffer_load_dwordx4 v22, s[8:11], s58 offen offset:2048 lds
    s_lshl_b32 s32, s44, 2
    v_mfma_f32_32x32x16_bf16 v[64:79], a[40:43], v[168:171], v[64:79]
    v_xor_b32 v24, 65536, v24
    v_xor_b32 v25, 65536, v25
    v_mfma_f32_32x32x16_bf16 v[80:95], a[168:171], v[168:171], v[80:95]
    buffer_load_dwordx4 v23, s[12:15], s58 offen offset:3072 lds
    s_add_u32 s32, s32, s42
    s_lshl_b32 s34, s34, 1
    v_mfma_f32_32x32x16_bf16 v[64:79], a[44:47], v[172:175], v[64:79]
    s_waitcnt vmcnt(9) lgkmcnt(0)
    s_barrier
    v_mfma_f32_32x32x16_bf16 v[80:95], a[172:175], v[172:175], v[80:95]
    ds_read_b64_tr_b16 a[64:65], v24 offset:0
    ds_read_b64_tr_b16 a[66:67], v24 offset:512
    ds_read_b64_tr_b16 a[192:193], v25 offset:0
    ds_read_b64_tr_b16 a[194:195], v25 offset:512
    s_lshl_b32 s50, s17, 10
    s_add_u32 s50, s50, s36
    v_mfma_f32_32x32x16_bf16 v[64:79], a[48:51], v[176:179], v[64:79]
    ds_read_b64_tr_b16 a[68:69], v24 offset:4096
    ds_read_b64_tr_b16 a[70:71], v24 offset:4608
    ds_read_b64_tr_b16 a[196:197], v25 offset:4096
    s_add_u32 m0, s52, 65536
    s_add_u32 s58, s50, s28
    s_mul_i32 s32, s32, 57344
    v_mfma_f32_32x32x16_bf16 v[80:95], a[176:179], v[176:179], v[80:95]
    ds_read_b64_tr_b16 a[198:199], v25 offset:4608
    ds_read_b64_tr_b16 a[72:73], v24 offset:8192
    ds_read_b64_tr_b16 a[74:75], v24 offset:8704
    buffer_load_dwordx4 v8, s[4:7], s58 offen lds
    v_mfma_f32_32x32x16_bf16 v[64:79], a[52:55], v[180:183], v[64:79]
    ds_read_b64_tr_b16 a[200:201], v25 offset:8192
    ds_read_b64_tr_b16 a[202:203], v25 offset:8704
    ds_read_b64_tr_b16 a[76:77], v24 offset:12288
    s_add_u32 s32, s32, 12582912
    s_lshl_b32 s33, s57, 2
    s_add_u32 s34, s34, s49
    v_mfma_f32_32x32x16_bf16 v[80:95], a[180:183], v[180:183], v[80:95]
    ds_read_b64_tr_b16 a[78:79], v24 offset:12800
    ds_read_b64_tr_b16 a[204:205], v25 offset:12288
    ds_read_b64_tr_b16 a[206:207], v25 offset:12800
    buffer_load_dwordx4 v9, s[4:7], s58 offen offset:1024 lds
    v_mfma_f32_32x32x16_bf16 v[64:79], a[56:59], v[184:187], v[64:79]
    ds_read_b64_tr_b16 a[80:81], v24 offset:16384
    ds_read_b64_tr_b16 a[82:83], v24 offset:16896
    s_add_u32 s33, s33, s42
    s_mul_i32 s33, s33, 57344
    s_lshl_b32 s34, s34, 10
    v_mfma_f32_32x32x16_bf16 v[80:95], a[184:187], v[184:187], v[80:95]
    ds_read_b64_tr_b16 a[208:209], v25 offset:16384
    ds_read_b64_tr_b16 a[210:211], v25 offset:16896
    s_add_u32 s33, s33, 5242880
    v_mfma_f32_32x32x16_bf16 v[64:79], a[60:63], v[188:191], v[64:79]
    ds_read_b64_tr_b16 a[84:85], v24 offset:20480
    ds_read_b64_tr_b16 a[86:87], v24 offset:20992
    buffer_load_dwordx4 v10, s[4:7], s58 offen offset:2048 lds
    s_and_b32 s69, s57, 28
    v_mfma_f32_32x32x16_bf16 v[80:95], a[188:191], v[188:191], v[80:95]
    ds_read_b64_tr_b16 a[212:213], v25 offset:20480
    ds_read_b64_tr_b16 a[214:215], v25 offset:20992
    s_mul_i32 s69, s69, 3584
    s_waitcnt lgkmcnt(6)
    v_mfma_f32_32x32x16_bf16 v[64:79], a[64:67], v[192:195], v[64:79]
    ds_read_b64_tr_b16 a[88:89], v24 offset:24576
    ds_read_b64_tr_b16 a[90:91], v24 offset:25088
    buffer_load_dwordx4 v11, s[4:7], s58 offen offset:3072 lds
    s_add_u32 s34, s34, 5242880
    v_mfma_f32_32x32x16_bf16 v[80:95], a[192:195], v[192:195], v[80:95]
    ds_read_b64_tr_b16 a[216:217], v25 offset:24576
    ds_read_b64_tr_b16 a[218:219], v25 offset:25088
    s_add_u32 s69, s69, 524288
    v_mfma_f32_32x32x16_bf16 v[64:79], a[68:71], v[196:199], v[64:79]
    ds_read_b64_tr_b16 a[92:93], v24 offset:28672
    ds_read_b64_tr_b16 a[94:95], v24 offset:29184
    s_add_u32 m0, s52, 81920
    s_add_u32 s58, s50, s29
    s_lshl_b32 s59, s42, 1
    v_add_u32 v31, s59, v0
    v_mfma_f32_32x32x16_bf16 v[80:95], a[196:199], v[196:199], v[80:95]
    ds_read_b64_tr_b16 a[220:221], v25 offset:28672
    ds_read_b64_tr_b16 a[222:223], v25 offset:29184
    buffer_load_dwordx4 v8, s[4:7], s58 offen lds
    s_lshl_b32 s35, s42, 17
    v_mfma_f32_32x32x16_bf16 v[64:79], a[72:75], v[200:203], v[64:79]
    v_min_u32 v31, 6, v31
    v_mfma_f32_32x32x16_bf16 v[80:95], a[200:203], v[200:203], v[80:95]
    buffer_load_dwordx4 v9, s[4:7], s58 offen offset:1024 lds
    v_mfma_f32_32x32x16_bf16 v[64:79], a[76:79], v[204:207], v[64:79]
    s_waitcnt vmcnt(6) lgkmcnt(0)
    s_barrier
    v_mfma_f32_32x32x16_bf16 v[80:95], a[204:207], v[204:207], v[80:95]
    ds_read_b64_tr_b16 a[96:97], v24 offset:32768
    ds_read_b64_tr_b16 a[98:99], v24 offset:33280
    ds_read_b64_tr_b16 a[224:225], v25 offset:32768
    ds_read_b64_tr_b16 a[226:227], v25 offset:33280
    s_add_u32 s35, s35, s46
    v_lshl_add_u32 v5, v31, 7, s69
    v_mfma_f32_32x32x16_bf16 v[64:79], a[80:83], v[208:211], v[64:79]
    ds_read_b64_tr_b16 a[100:101], v24 offset:36864
    ds_read_b64_tr_b16 a[102:103], v24 offset:37376
    ds_read_b64_tr_b16 a[228:229], v25 offset:36864
    buffer_load_dwordx4 v10, s[4:7], s58 offen offset:2048 lds
    v_mfma_f32_32x32x16_bf16 v[80:95], a[208:211], v[208:211], v[80:95]
    ds_read_b64_tr_b16 a[230:231], v25 offset:37376
    ds_read_b64_tr_b16 a[104:105], v24 offset:40960
    ds_read_b64_tr_b16 a[106:107], v24 offset:41472
    ds_read_b64_tr_b16 a[232:233], v25 offset:40960
    v_lshrrev_b32 v31, 1, v0
    v_min_u32 v31, 1, v31
    v_mfma_f32_32x32x16_bf16 v[64:79], a[84:87], v[212:215], v[64:79]
    ds_read_b64_tr_b16 a[234:235], v25 offset:41472
    ds_read_b64_tr_b16 a[108:109], v24 offset:45056
    buffer_load_dwordx4 v11, s[4:7], s58 offen offset:3072 lds
    v_lshl_add_u32 v5, v31, 30, v5
    v_mfma_f32_32x32x16_bf16 v[80:95], a[212:215], v[212:215], v[80:95]
    ds_read_b64_tr_b16 a[110:111], v24 offset:45568
    ds_read_b64_tr_b16 a[236:237], v25 offset:45056
    ds_read_b64_tr_b16 a[238:239], v25 offset:45568
    s_add_u32 m0, s52, 98304
    s_add_u32 s58, s50, s30
    s_mul_i32 s35, s35, 28
    v_mfma_f32_32x32x16_bf16 v[64:79], a[88:91], v[216:219], v[64:79]
    ds_read_b64_tr_b16 a[112:113], v24 offset:49152
    ds_read_b64_tr_b16 a[114:115], v24 offset:49664
    buffer_load_dwordx4 v8, s[4:7], s58 offen lds
    v_and_b32 v31, 7, v0
    v_mfma_f32_32x32x16_bf16 v[80:95], a[216:219], v[216:219], v[80:95]
    ds_read_b64_tr_b16 a[240:241], v25 offset:49152
    ds_read_b64_tr_b16 a[242:243], v25 offset:49664
    s_lshr_b32 s59, s44, 1
    s_lshl_b32 s59, s59, 2
    s_add_u32 s59, s59, s42
    s_lshl_b32 s63, s59, 7
    v_mfma_f32_32x32x16_bf16 v[64:79], a[92:95], v[220:223], v[64:79]
    ds_read_b64_tr_b16 a[116:117], v24 offset:53248
    ds_read_b64_tr_b16 a[118:119], v24 offset:53760
    s_add_u32 s35, s35, s47
    v_mfma_f32_32x32x16_bf16 v[80:95], a[220:223], v[220:223], v[80:95]
    ds_read_b64_tr_b16 a[244:245], v25 offset:53248
    ds_read_b64_tr_b16 a[246:247], v25 offset:53760
    buffer_load_dwordx4 v9, s[4:7], s58 offen offset:1024 lds
    s_waitcnt lgkmcnt(6)
    v_mfma_f32_32x32x16_bf16 v[64:79], a[96:99], v[224:227], v[64:79]
    ds_read_b64_tr_b16 a[120:121], v24 offset:57344
    ds_read_b64_tr_b16 a[122:123], v24 offset:57856
    v_mfma_f32_32x32x16_bf16 v[80:95], a[224:227], v[224:227], v[80:95]
    ds_read_b64_tr_b16 a[248:249], v25 offset:57344
    ds_read_b64_tr_b16 a[250:251], v25 offset:57856
    buffer_load_dwordx4 v10, s[4:7], s58 offen offset:2048 lds
    s_lshl_b32 s35, s35, 7
    v_mfma_f32_32x32x16_bf16 v[64:79], a[100:103], v[228:231], v[64:79]
    ds_read_b64_tr_b16 a[124:125], v24 offset:61440
    ds_read_b64_tr_b16 a[126:127], v24 offset:61952
    s_add_u32 s59, s63, 98304
    v_lshl_add_u32 v28, v31, 12, s59
    v_mfma_f32_32x32x16_bf16 v[80:95], a[228:231], v[228:231], v[80:95]
    ds_read_b64_tr_b16 a[252:253], v25 offset:61440
    ds_read_b64_tr_b16 a[254:255], v25 offset:61952
    buffer_load_dwordx4 v11, s[4:7], s58 offen offset:3072 lds
    v_mfma_f32_32x32x16_bf16 v[64:79], a[104:107], v[232:235], v[64:79]
    v_bfe_u32 v31, v0, 3, 1
    v_mfma_f32_32x32x16_bf16 v[80:95], a[232:235], v[232:235], v[80:95]
    s_add_u32 m0, s52, 114688
    s_add_u32 s58, s50, s31
    s_add_u32 s35, s35, 524288
    v_mfma_f32_32x32x16_bf16 v[64:79], a[108:111], v[236:239], v[64:79]
    s_waitcnt vmcnt(8) lgkmcnt(0)
    s_barrier
    v_mfma_f32_32x32x16_bf16 v[80:95], a[236:239], v[236:239], v[80:95]
    buffer_load_dwordx4 v8, s[4:7], s58 offen lds
    v_lshl_add_u32 v28, v31, 11, v28
    v_lshrrev_b32 v31, 4, v0
    v_mfma_f32_32x32x16_bf16 v[64:79], a[112:115], v[240:243], v[64:79]
    ds_read_b128 v[96:99], v12 offset:0
    ds_read_b128 v[100:103], v13 offset:0
    s_mov_b32 s62, 0xbdd2d3e8
    v_lshl_add_u32 v28, v31, 28, v28
    v_mfma_f32_32x32x16_bf16 v[80:95], a[240:243], v[240:243], v[80:95]
    ds_read_b128 v[104:107], v14 offset:0
    ds_read_b128 v[108:111], v15 offset:0
    buffer_load_dwordx4 v9, s[4:7], s58 offen offset:1024 lds
    v_mfma_f32_32x32x16_bf16 v[64:79], a[116:119], v[244:247], v[64:79]
    v_mfma_f32_32x32x16_bf16 v[80:95], a[244:247], v[244:247], v[80:95]
    v_mfma_f32_32x32x16_bf16 v[64:79], a[120:123], v[248:251], v[64:79]
    buffer_load_dwordx4 v10, s[4:7], s58 offen offset:2048 lds
    v_mfma_f32_32x32x16_bf16 v[80:95], a[248:251], v[248:251], v[80:95]
    s_branch L_ld_m2
.p2align 12
L_st_m2:
L_wA_m2:
    s_branch L_retA
L_ld_m2:
    v_mfma_f32_32x32x16_bf16 v[64:79], a[124:127], v[252:255], v[64:79]
    buffer_load_dwordx4 v11, s[4:7], s58 offen offset:3072 lds
    v_mfma_f32_32x32x16_bf16 v[80:95], a[252:255], v[252:255], v[80:95]
    v_mov_b32 v24, 0xc0135761
    s_waitcnt lgkmcnt(0)
    v_mfma_f32_32x32x16_bf16 v[32:47], a[0:3], v[96:99], 0
    ds_read_b128 v[112:115], v16 offset:0
    s_mov_b32 s8, 0
    s_lshl_b32 s50, s18, 10
    s_add_u32 s50, s50, s36
    s_add_u32 m0, s52, 0
    s_add_u32 s58, s50, s28
    v_mfma_f32_32x32x16_bf16 v[48:63], a[128:131], v[96:99], 0
    ds_read_b128 v[116:119], v17 offset:0
    buffer_load_dwordx4 v8, s[4:7], s58 offen lds
    v_mfma_f32_32x32x16_bf16 v[32:47], a[4:7], v[100:103], v[32:47]
    ds_read_b128 v[120:123], v18 offset:0
    buffer_load_dwordx4 v9, s[4:7], s58 offen offset:1024 lds
    v_mul_f32 v128, v64, v64
    v_mul_f32 v129, v65, v65
    v_mfma_f32_32x32x16_bf16 v[48:63], a[132:135], v[100:103], v[48:63]
    ds_read_b128 v[124:127], v19 offset:0
    v_mul_f32 v130, v66, v66
    v_mul_f32 v131, v67, v67
    v_fma_f32 v128, v128, s62, v24
    v_fma_f32 v129, v129, s62, v24
    v_fma_f32 v130, v130, s62, v24
    v_mfma_f32_32x32x16_bf16 v[32:47], a[8:11], v[104:107], v[32:47]
    s_mov_b32 s9, 2048
    buffer_load_dwordx2 v[30:31], v28, s[20:23], 0 offen sc1
    v_fma_f32 v131, v131, s62, v24
    v_mul_f32 v128, v128, v64
    v_mul_f32 v129, v129, v65
    v_mfma_f32_32x32x16_bf16 v[48:63], a[136:139], v[104:107], v[48:63]
    v_mul_f32 v130, v130, v66
    v_mul_f32 v131, v131, v67
    v_exp_f32 v128, v128
    v_mul_f32 v132, v64, v72
    v_mfma_f32_32x32x16_bf16 v[32:47], a[12:15], v[108:111], v[32:47]
    buffer_load_dwordx4 v10, s[4:7], s58 offen offset:2048 lds
    v_exp_f32 v129, v129
    v_mul_f32 v133, v65, v73
    v_mfma_f32_32x32x16_bf16 v[48:63], a[140:143], v[108:111], v[48:63]
    s_waitcnt vmcnt(12)
    s_barrier
    s_waitcnt lgkmcnt(0)
    v_mfma_f32_32x32x16_bf16 v[32:47], a[16:19], v[112:115], v[32:47]
    ds_read_b128 v[96:99], v12 offset:16384
    s_mov_b32 s10, 4096
    buffer_load_dwordx4 v11, s[4:7], s58 offen offset:3072 lds
    v_mfma_f32_32x32x16_bf16 v[48:63], a[144:147], v[112:115], v[48:63]
    ds_read_b128 v[100:103], v13 offset:16384
    s_add_u32 m0, s52, 16384
    s_add_u32 s58, s50, s29
    v_exp_f32 v130, v130
    v_mul_f32 v134, v66, v74
    v_mfma_f32_32x32x16_bf16 v[32:47], a[20:23], v[116:119], v[32:47]
    ds_read_b128 v[104:107], v14 offset:16384
    buffer_load_dwordx4 v8, s[4:7], s58 offen lds
    v_exp_f32 v131, v131
    v_mfma_f32_32x32x16_bf16 v[48:63], a[148:151], v[116:119], v[48:63]
    ds_read_b128 v[108:111], v15 offset:16384
    v_mul_f32 v135, v67, v75
    v_add_f32 v128, 1.0, v128
    v_add_f32 v129, 1.0, v129
    v_add_f32 v130, 1.0, v130
    v_add_f32 v131, 1.0, v131
    v_mfma_f32_32x32x16_bf16 v[32:47], a[24:27], v[120:123], v[32:47]
    s_mov_b32 s11, 6144
    v_rcp_f32 v128, v128
    v_rcp_f32 v129, v129
    v_mfma_f32_32x32x16_bf16 v[48:63], a[152:155], v[120:123], v[48:63]
    buffer_load_dwordx4 v9, s[4:7], s58 offen offset:1024 lds
    v_rcp_f32 v130, v130
    v_rcp_f32 v131, v131
    v_mfma_f32_32x32x16_bf16 v[32:47], a[28:31], v[124:127], v[32:47]
    v_mul_f32 v132, v132, v128
    v_mul_f32 v133, v133, v129
    v_mul_f32 v134, v134, v130
    v_mul_f32 v135, v135, v131
    v_cvt_pk_bf16_f32 v144, v132, v133
    v_cvt_pk_bf16_f32 v145, v134, v135
    v_mfma_f32_32x32x16_bf16 v[48:63], a[156:159], v[124:127], v[48:63]
    buffer_load_dwordx4 v10, s[4:7], s58 offen offset:2048 lds
    v_mul_f32 v136, v68, v68
    v_mul_f32 v137, v69, v69
    v_mul_f32 v138, v70, v70
    v_mul_f32 v139, v71, v71
    s_waitcnt lgkmcnt(0)
    v_mfma_f32_32x32x16_bf16 v[32:47], a[32:35], v[96:99], v[32:47]
    ds_read_b128 v[112:115], v16 offset:16384
    s_mov_b32 s12, 8192
    v_fma_f32 v136, v136, s62, v24
    v_fma_f32 v137, v137, s62, v24
    v_fma_f32 v138, v138, s62, v24
    v_fma_f32 v139, v139, s62, v24
    v_mfma_f32_32x32x16_bf16 v[48:63], a[160:163], v[96:99], v[48:63]
    ds_read_b128 v[116:119], v17 offset:16384
    buffer_load_dwordx4 v11, s[4:7], s58 offen offset:3072 lds
    v_mul_f32 v136, v136, v68
    v_mul_f32 v137, v137, v69
    v_mfma_f32_32x32x16_bf16 v[32:47], a[36:39], v[100:103], v[32:47]
    ds_read_b128 v[120:123], v18 offset:16384
    s_add_u32 m0, s52, 32768
    s_add_u32 s58, s50, s30
    v_mul_f32 v138, v138, v70
    v_mul_f32 v139, v139, v71
    v_mfma_f32_32x32x16_bf16 v[48:63], a[164:167], v[100:103], v[48:63]
    ds_read_b128 v[124:127], v19 offset:16384
    buffer_load_dwordx4 v8, s[4:7], s58 offen lds
    v_exp_f32 v136, v136
    v_mfma_f32_32x32x16_bf16 v[32:47], a[40:43], v[104:107], v[32:47]
    s_mov_b32 s13, 10240
    v_mul_f32 v140, v68, v76
    v_exp_f32 v137, v137
    v_mul_f32 v141, v69, v77
    v_mfma_f32_32x32x16_bf16 v[48:63], a[168:171], v[104:107], v[48:63]
    buffer_load_dwordx4 v9, s[4:7], s58 offen offset:1024 lds
    v_exp_f32 v138, v138
    v_mul_f32 v142, v70, v78
    v_mfma_f32_32x32x16_bf16 v[32:47], a[44:47], v[108:111], v[32:47]
    v_exp_f32 v139, v139
    v_mul_f32 v143, v71, v79
    v_add_f32 v136, 1.0, v136
    v_add_f32 v137, 1.0, v137
    v_add_f32 v138, 1.0, v138
    v_mfma_f32_32x32x16_bf16 v[48:63], a[172:175], v[108:111], v[48:63]
    s_waitcnt vmcnt(8)
    v_cmp_ne_u64 vcc, s[40:41], v[30:31]
    s_nop 0
    s_and_b32 s68, vcc_lo, 32639
    s_cbranch_scc1 L_pr1
L_pd1:
    s_barrier
    s_waitcnt lgkmcnt(0)
    v_mfma_f32_32x32x16_bf16 v[32:47], a[48:51], v[112:115], v[32:47]
    ds_read_b128 v[96:99], v12 offset:32768
    s_mov_b32 s14, 12288
    buffer_load_dwordx4 v10, s[4:7], s58 offen offset:2048 lds
    v_add_f32 v139, 1.0, v139
    v_mfma_f32_32x32x16_bf16 v[48:63], a[176:179], v[112:115], v[48:63]
    ds_read_b128 v[100:103], v13 offset:32768
    buffer_load_dwordx4 v11, s[4:7], s58 offen offset:3072 lds
    v_rcp_f32 v136, v136
    v_mfma_f32_32x32x16_bf16 v[32:47], a[52:55], v[116:119], v[32:47]
    ds_read_b128 v[104:107], v14 offset:32768
    s_add_u32 m0, s52, 49152
    s_add_u32 s58, s50, s31
    v_rcp_f32 v137, v137
    v_mfma_f32_32x32x16_bf16 v[48:63], a[180:183], v[116:119], v[48:63]
    ds_read_b128 v[108:111], v15 offset:32768
    buffer_load_dwordx4 v8, s[4:7], s58 offen lds
    v_rcp_f32 v138, v138
    v_mfma_f32_32x32x16_bf16 v[32:47], a[56:59], v[120:123], v[32:47]
    v_rcp_f32 v139, v139
    v_mul_f32 v140, v140, v136
    v_mul_f32 v141, v141, v137
    v_mul_f32 v142, v142, v138
    v_mul_f32 v143, v143, v139
    v_mfma_f32_32x32x16_bf16 v[48:63], a[184:187], v[120:123], v[48:63]
    buffer_load_dwordx4 v9, s[4:7], s58 offen offset:1024 lds
    v_cvt_pk_bf16_f32 v146, v140, v141
    v_cvt_pk_bf16_f32 v147, v142, v143
    v_mul_f32 v128, v80, v80
    v_mul_f32 v129, v81, v81
    v_mfma_f32_32x32x16_bf16 v[32:47], a[60:63], v[124:127], v[32:47]
    v_mul_f32 v130, v82, v82
    v_mul_f32 v131, v83, v83
    v_fma_f32 v128, v128, s62, v24
    v_fma_f32 v129, v129, s62, v24
    v_fma_f32 v130, v130, s62, v24
    v_fma_f32 v131, v131, s62, v24
    v_mfma_f32_32x32x16_bf16 v[48:63], a[188:191], v[124:127], v[48:63]
    v_mul_f32 v128, v128, v80
    v_mul_f32 v129, v129, v81
    v_mul_f32 v130, v130, v82
    v_mul_f32 v131, v131, v83
    v_exp_f32 v128, v128
    s_waitcnt lgkmcnt(0)
    v_mfma_f32_32x32x16_bf16 v[32:47], a[64:67], v[96:99], v[32:47]
    ds_read_b128 v[112:115], v16 offset:32768
    buffer_load_dwordx4 v10, s[4:7], s58 offen offset:2048 lds
    v_mul_f32 v132, v80, v88
    v_mfma_f32_32x32x16_bf16 v[48:63], a[192:195], v[96:99], v[48:63]
    ds_read_b128 v[116:119], v17 offset:32768
    v_exp_f32 v129, v129
    v_mul_f32 v133, v81, v89
    v_exp_f32 v130, v130
    v_mfma_f32_32x32x16_bf16 v[32:47], a[68:71], v[100:103], v[32:47]
    ds_read_b128 v[120:123], v18 offset:32768
    buffer_load_dwordx4 v11, s[4:7], s58 offen offset:3072 lds
    v_mul_f32 v134, v82, v90
    v_mfma_f32_32x32x16_bf16 v[48:63], a[196:199], v[100:103], v[48:63]
    ds_read_b128 v[124:127], v19 offset:32768
    s_mul_i32 s15, s64, 14336
    s_add_u32 s15, s15, s32
    s_add_u32 s37, s15, s8
    v_exp_f32 v131, v131
    v_mfma_f32_32x32x16_bf16 v[32:47], a[72:75], v[104:107], v[32:47]
    buffer_load_dwordx4 v[160:163], v1, s[20:23], s37 offen offset:0 sc1
    v_mul_f32 v135, v83, v91
    v_add_f32 v128, 1.0, v128
    v_add_f32 v129, 1.0, v129
    v_add_f32 v130, 1.0, v130
    v_mfma_f32_32x32x16_bf16 v[48:63], a[200:203], v[104:107], v[48:63]
    v_add_f32 v131, 1.0, v131
    v_rcp_f32 v128, v128
    v_rcp_f32 v129, v129
    v_mfma_f32_32x32x16_bf16 v[32:47], a[76:79], v[108:111], v[32:47]
    buffer_load_dwordx4 v[164:167], v1, s[20:23], s37 offen offset:1024 sc1
    v_rcp_f32 v130, v130
    v_rcp_f32 v131, v131
    v_mfma_f32_32x32x16_bf16 v[48:63], a[204:207], v[108:111], v[48:63]
    s_add_u32 s37, s15, s9
    v_mul_f32 v132, v132, v128
    v_mul_f32 v133, v133, v129
    v_mul_f32 v134, v134, v130
    v_mul_f32 v135, v135, v131
    v_cvt_pk_bf16_f32 v148, v132, v133
    s_waitcnt lgkmcnt(0)
    v_mfma_f32_32x32x16_bf16 v[32:47], a[80:83], v[112:115], v[32:47]
    ds_read_b128 v[96:99], v12 offset:49152
    buffer_load_dwordx4 v[168:171], v1, s[20:23], s37 offen offset:0 sc1
    v_cvt_pk_bf16_f32 v149, v134, v135
    v_mul_f32 v136, v84, v84
    v_mfma_f32_32x32x16_bf16 v[48:63], a[208:211], v[112:115], v[48:63]
    ds_read_b128 v[100:103], v13 offset:49152
    v_mul_f32 v137, v85, v85
    v_mul_f32 v138, v86, v86
    v_mul_f32 v139, v87, v87
    v_fma_f32 v136, v136, s62, v24
    v_fma_f32 v137, v137, s62, v24
    v_mfma_f32_32x32x16_bf16 v[32:47], a[84:87], v[116:119], v[32:47]
    ds_read_b128 v[104:107], v14 offset:49152
    buffer_load_dwordx4 v[172:175], v1, s[20:23], s37 offen offset:1024 sc1
    v_fma_f32 v138, v138, s62, v24
    v_fma_f32 v139, v139, s62, v24
    v_mfma_f32_32x32x16_bf16 v[48:63], a[212:215], v[116:119], v[48:63]
    ds_read_b128 v[108:111], v15 offset:49152
    s_add_u32 s37, s15, s10
    v_mul_f32 v136, v136, v84
    v_mul_f32 v137, v137, v85
    v_mul_f32 v138, v138, v86
    v_mul_f32 v139, v139, v87
    v_mfma_f32_32x32x16_bf16 v[32:47], a[88:91], v[120:123], v[32:47]
    buffer_load_dwordx4 v[176:179], v1, s[20:23], s37 offen offset:0 sc1
    v_exp_f32 v136, v136
    v_mul_f32 v140, v84, v92
    v_mfma_f32_32x32x16_bf16 v[48:63], a[216:219], v[120:123], v[48:63]
    v_exp_f32 v137, v137
    v_mul_f32 v141, v85, v93
    v_exp_f32 v138, v138
    v_mul_f32 v142, v86, v94
    v_mfma_f32_32x32x16_bf16 v[32:47], a[92:95], v[124:127], v[32:47]
    v_xor_b32 v12, 65536, v12
    v_exp_f32 v139, v139
    v_mul_f32 v143, v87, v95
    v_add_f32 v136, 1.0, v136
    v_add_f32 v137, 1.0, v137
    v_mfma_f32_32x32x16_bf16 v[48:63], a[220:223], v[124:127], v[48:63]
    v_add_f32 v138, 1.0, v138
    v_add_f32 v139, 1.0, v139
    v_rcp_f32 v136, v136
    v_rcp_f32 v137, v137
    v_rcp_f32 v138, v138
    v_rcp_f32 v139, v139
    v_mul_f32 v140, v140, v136
    v_mul_f32 v141, v141, v137
    v_mul_f32 v142, v142, v138
    v_mul_f32 v143, v143, v139
    v_cvt_pk_bf16_f32 v150, v140, v141
    v_cvt_pk_bf16_f32 v151, v142, v143
    s_waitcnt lgkmcnt(0)
    v_mfma_f32_32x32x16_bf16 v[32:47], a[96:99], v[96:99], v[32:47]
    ds_read_b128 v[112:115], v16 offset:49152
    s_mul_i32 s53, s16, 229376
    s_add_u32 s53, s53, s34
    s_add_u32 s47, s53, 57344
    v_xor_b32 v13, 65536, v13
    v_mfma_f32_32x32x16_bf16 v[48:63], a[224:227], v[96:99], v[48:63]
    ds_read_b128 v[116:119], v17 offset:49152
    buffer_store_dwordx4 v[144:147], v1, s[20:23], s53 offen sc1
    v_mfma_f32_32x32x16_bf16 v[32:47], a[100:103], v[100:103], v[32:47]
    ds_read_b128 v[120:123], v18 offset:49152
    v_xor_b32 v14, 65536, v14
    v_mfma_f32_32x32x16_bf16 v[48:63], a[228:231], v[100:103], v[48:63]
    ds_read_b128 v[124:127], v19 offset:49152
    buffer_store_dwordx4 v[148:151], v1, s[20:23], s47 offen sc1
    v_mfma_f32_32x32x16_bf16 v[32:47], a[104:107], v[104:107], v[32:47]
    v_xor_b32 v15, 65536, v15
    v_mfma_f32_32x32x16_bf16 v[48:63], a[232:235], v[104:107], v[48:63]
    v_mfma_f32_32x32x16_bf16 v[32:47], a[108:111], v[108:111], v[32:47]
    v_mfma_f32_32x32x16_bf16 v[48:63], a[236:239], v[108:111], v[48:63]
    s_waitcnt vmcnt(7) lgkmcnt(0)
    s_barrier
    v_mfma_f32_32x32x16_bf16 v[32:47], a[112:115], v[112:115], v[32:47]
    ds_read_b128 v[96:99], v12 offset:0
    s_lshl_b32 s50, s19, 10
    s_add_u32 s50, s50, s36
    s_add_u32 m0, s52, 65536
    s_add_u32 s58, s50, s28
    v_xor_b32 v16, 65536, v16
    v_mfma_f32_32x32x16_bf16 v[48:63], a[240:243], v[112:115], v[48:63]
    ds_read_b128 v[100:103], v13 offset:0
    buffer_load_dwordx4 v8, s[4:7], s58 offen lds
    v_mfma_f32_32x32x16_bf16 v[32:47], a[116:119], v[116:119], v[32:47]
    ds_read_b128 v[104:107], v14 offset:0
    v_xor_b32 v17, 65536, v17
    v_mfma_f32_32x32x16_bf16 v[48:63], a[244:247], v[116:119], v[48:63]
    ds_read_b128 v[108:111], v15 offset:0
    buffer_load_dwordx4 v9, s[4:7], s58 offen offset:1024 lds
    v_mfma_f32_32x32x16_bf16 v[32:47], a[120:123], v[120:123], v[32:47]
    v_xor_b32 v18, 65536, v18
    v_mfma_f32_32x32x16_bf16 v[48:63], a[248:251], v[120:123], v[48:63]
    buffer_load_dwordx4 v10, s[4:7], s58 offen offset:2048 lds
    v_mfma_f32_32x32x16_bf16 v[32:47], a[124:127], v[124:127], v[32:47]
    v_xor_b32 v19, 65536, v19
    v_mfma_f32_32x32x16_bf16 v[48:63], a[252:255], v[124:127], v[48:63]
    buffer_load_dwordx4 v11, s[4:7], s58 offen offset:3072 lds
    s_waitcnt lgkmcnt(0)
    v_mfma_f32_32x32x16_bf16 v[64:79], a[0:3], v[96:99], 0
    ds_read_b128 v[112:115], v16 offset:0
    s_add_u32 m0, s52, 81920
    s_add_u32 s58, s50, s29
    v_mfma_f32_32x32x16_bf16 v[80:95], a[128:131], v[96:99], 0
    ds_read_b128 v[116:119], v17 offset:0
    buffer_load_dwordx4 v8, s[4:7], s58 offen lds
    v_mfma_f32_32x32x16_bf16 v[64:79], a[4:7], v[100:103], v[64:79]
    ds_read_b128 v[120:123], v18 offset:0
    v_mul_f32 v128, v32, v32
    v_mul_f32 v129, v33, v33
    v_mul_f32 v130, v34, v34
    v_mul_f32 v131, v35, v35
    v_fma_f32 v128, v128, s62, v24
    v_mfma_f32_32x32x16_bf16 v[80:95], a[132:135], v[100:103], v[80:95]
    ds_read_b128 v[124:127], v19 offset:0
    buffer_load_dwordx4 v9, s[4:7], s58 offen offset:1024 lds
    v_fma_f32 v129, v129, s62, v24
    v_fma_f32 v130, v130, s62, v24
    v_mfma_f32_32x32x16_bf16 v[64:79], a[8:11], v[104:107], v[64:79]
    v_fma_f32 v131, v131, s62, v24
    v_mul_f32 v128, v128, v32
    v_mul_f32 v129, v129, v33
    v_mul_f32 v130, v130, v34
    v_mul_f32 v131, v131, v35
    v_mfma_f32_32x32x16_bf16 v[80:95], a[136:139], v[104:107], v[80:95]
    v_exp_f32 v128, v128
    v_mul_f32 v132, v32, v40
    v_exp_f32 v129, v129
    v_mul_f32 v133, v33, v41
    v_mfma_f32_32x32x16_bf16 v[64:79], a[12:15], v[108:111], v[64:79]
    buffer_load_dwordx4 v10, s[4:7], s58 offen offset:2048 lds
    v_exp_f32 v130, v130
    v_mul_f32 v134, v34, v42
    v_mfma_f32_32x32x16_bf16 v[80:95], a[140:143], v[108:111], v[80:95]
    v_exp_f32 v131, v131
    v_mul_f32 v135, v35, v43
    v_add_f32 v128, 1.0, v128
    v_add_f32 v129, 1.0, v129
    v_add_f32 v130, 1.0, v130
    s_waitcnt lgkmcnt(0)
    v_mfma_f32_32x32x16_bf16 v[64:79], a[16:19], v[112:115], v[64:79]
    ds_read_b128 v[96:99], v12 offset:16384
    buffer_load_dwordx4 v11, s[4:7], s58 offen offset:3072 lds
    v_add_f32 v131, 1.0, v131
    v_mfma_f32_32x32x16_bf16 v[80:95], a[144:147], v[112:115], v[80:95]
    ds_read_b128 v[100:103], v13 offset:16384
    s_add_u32 m0, s52, 98304
    s_add_u32 s58, s50, s30
    v_rcp_f32 v128, v128
    v_mfma_f32_32x32x16_bf16 v[64:79], a[20:23], v[116:119], v[64:79]
    ds_read_b128 v[104:107], v14 offset:16384
    buffer_load_dwordx4 v8, s[4:7], s58 offen lds
    v_rcp_f32 v129, v129
    v_mfma_f32_32x32x16_bf16 v[80:95], a[148:151], v[116:119], v[80:95]
    ds_read_b128 v[108:111], v15 offset:16384
    v_rcp_f32 v130, v130
    v_rcp_f32 v131, v131
    v_mul_f32 v132, v132, v128
    v_mfma_f32_32x32x16_bf16 v[64:79], a[24:27], v[120:123], v[64:79]
    buffer_load_dwordx4 v9, s[4:7], s58 offen offset:1024 lds
    v_mul_f32 v133, v133, v129
    v_mul_f32 v134, v134, v130
    v_mul_f32 v135, v135, v131
    v_cvt_pk_bf16_f32 v152, v132, v133
    v_mfma_f32_32x32x16_bf16 v[80:95], a[152:155], v[120:123], v[80:95]
    v_cvt_pk_bf16_f32 v153, v134, v135
    v_mul_f32 v136, v36, v36
    v_mul_f32 v137, v37, v37
    v_mul_f32 v138, v38, v38
    v_mul_f32 v139, v39, v39
    v_fma_f32 v136, v136, s62, v24
    v_mfma_f32_32x32x16_bf16 v[64:79], a[28:31], v[124:127], v[64:79]
    buffer_load_dwordx4 v10, s[4:7], s58 offen offset:2048 lds
    v_fma_f32 v137, v137, s62, v24
    v_fma_f32 v138, v138, s62, v24
    v_fma_f32 v139, v139, s62, v24
    v_mul_f32 v136, v136, v36
    v_mfma_f32_32x32x16_bf16 v[80:95], a[156:159], v[124:127], v[80:95]
    v_mul_f32 v137, v137, v37
    v_mul_f32 v138, v138, v38
    v_mul_f32 v139, v139, v39
    v_exp_f32 v136, v136
    v_mul_f32 v140, v36, v44
    s_waitcnt lgkmcnt(0)
    v_mfma_f32_32x32x16_bf16 v[64:79], a[32:35], v[96:99], v[64:79]
    ds_read_b128 v[112:115], v16 offset:16384
    buffer_load_dwordx4 v11, s[4:7], s58 offen offset:3072 lds
    v_exp_f32 v137, v137
    v_mfma_f32_32x32x16_bf16 v[80:95], a[160:163], v[96:99], v[80:95]
    ds_read_b128 v[116:119], v17 offset:16384
    s_add_u32 m0, s52, 114688
    s_add_u32 s58, s50, s31
    v_mul_f32 v141, v37, v45
    v_exp_f32 v138, v138
    v_mfma_f32_32x32x16_bf16 v[64:79], a[36:39], v[100:103], v[64:79]
    ds_read_b128 v[120:123], v18 offset:16384
    buffer_load_dwordx4 v8, s[4:7], s58 offen lds
    v_mul_f32 v142, v38, v46
    v_mfma_f32_32x32x16_bf16 v[80:95], a[164:167], v[100:103], v[80:95]
    ds_read_b128 v[124:127], v19 offset:16384
    v_exp_f32 v139, v139
    v_mul_f32 v143, v39, v47
    v_add_f32 v136, 1.0, v136
    v_add_f32 v137, 1.0, v137
    v_mfma_f32_32x32x16_bf16 v[64:79], a[40:43], v[104:107], v[64:79]
    buffer_load_dwordx4 v9, s[4:7], s58 offen offset:1024 lds
    v_add_f32 v138, 1.0, v138
    v_add_f32 v139, 1.0, v139
    v_rcp_f32 v136, v136
    v_mfma_f32_32x32x16_bf16 v[80:95], a[168:171], v[104:107], v[80:95]
    v_rcp_f32 v137, v137
    v_rcp_f32 v138, v138
    v_rcp_f32 v139, v139
    v_mfma_f32_32x32x16_bf16 v[64:79], a[44:47], v[108:111], v[64:79]
    buffer_load_dwordx4 v10, s[4:7], s58 offen offset:2048 lds
    v_mul_f32 v140, v140, v136
    v_mul_f32 v141, v141, v137
    v_mul_f32 v142, v142, v138
    v_mul_f32 v143, v143, v139
    v_mfma_f32_32x32x16_bf16 v[80:95], a[172:175], v[108:111], v[80:95]
    s_add_u32 s39, s35, 0
    s_waitcnt vmcnt(15)
    s_barrier
    s_waitcnt lgkmcnt(0)
    v_mfma_f32_32x32x16_bf16 v[64:79], a[48:51], v[112:115], v[64:79]
    ds_read_b128 v[96:99], v12 offset:32768
    buffer_store_dwordx2 v[6:7], v2, s[20:23], s39 offen sc1
    v_cvt_pk_bf16_f32 v154, v140, v141
    v_cvt_pk_bf16_f32 v155, v142, v143
    v_mfma_f32_32x32x16_bf16 v[80:95], a[176:179], v[112:115], v[80:95]
    ds_read_b128 v[100:103], v13 offset:32768
    buffer_load_dwordx4 v11, s[4:7], s58 offen offset:3072 lds
    v_mul_f32 v128, v48, v48
    v_mul_f32 v129, v49, v49
    v_mfma_f32_32x32x16_bf16 v[64:79], a[52:55], v[116:119], v[64:79]
    ds_read_b128 v[104:107], v14 offset:32768
    s_mul_i32 s15, s64, 14336
    s_add_u32 s15, s15, s32
    s_add_u32 s37, s15, s10
    v_mul_f32 v130, v50, v50
    v_mul_f32 v131, v51, v51
    v_mfma_f32_32x32x16_bf16 v[80:95], a[180:183], v[116:119], v[80:95]
    ds_read_b128 v[108:111], v15 offset:32768
    buffer_load_dwordx4 v[180:183], v1, s[20:23], s37 offen offset:1024 sc1
    v_fma_f32 v128, v128, s62, v24
    v_fma_f32 v129, v129, s62, v24
    v_mfma_f32_32x32x16_bf16 v[64:79], a[56:59], v[120:123], v[64:79]
    s_add_u32 s37, s15, s11
    v_fma_f32 v130, v130, s62, v24
    v_fma_f32 v131, v131, s62, v24
    v_mul_f32 v128, v128, v48
    v_mul_f32 v129, v129, v49
    v_mul_f32 v130, v130, v50
    v_mfma_f32_32x32x16_bf16 v[80:95], a[184:187], v[120:123], v[80:95]
    buffer_load_dwordx4 v[184:187], v1, s[20:23], s37 offen offset:0 sc1
    v_mul_f32 v131, v131, v51
    v_exp_f32 v128, v128
    v_mul_f32 v132, v48, v56
    v_mfma_f32_32x32x16_bf16 v[64:79], a[60:63], v[124:127], v[64:79]
    v_exp_f32 v129, v129
    v_mul_f32 v133, v49, v57
    v_exp_f32 v130, v130
    v_mul_f32 v134, v50, v58
    v_mfma_f32_32x32x16_bf16 v[80:95], a[188:191], v[124:127], v[80:95]
    buffer_load_dwordx4 v[188:191], v1, s[20:23], s37 offen offset:1024 sc1
    v_exp_f32 v131, v131
    v_mul_f32 v135, v51, v59
    v_add_f32 v128, 1.0, v128
    s_waitcnt lgkmcnt(0)
    v_mfma_f32_32x32x16_bf16 v[64:79], a[64:67], v[96:99], v[64:79]
    ds_read_b128 v[112:115], v16 offset:32768
    s_add_u32 s37, s15, s12
    v_add_f32 v129, 1.0, v129
    v_add_f32 v130, 1.0, v130
    v_add_f32 v131, 1.0, v131
    v_mfma_f32_32x32x16_bf16 v[80:95], a[192:195], v[96:99], v[80:95]
    ds_read_b128 v[116:119], v17 offset:32768
    buffer_load_dwordx4 v[192:195], v1, s[20:23], s37 offen offset:0 sc1
    v_rcp_f32 v128, v128
    v_mfma_f32_32x32x16_bf16 v[64:79], a[68:71], v[100:103], v[64:79]
    ds_read_b128 v[120:123], v18 offset:32768
    v_rcp_f32 v129, v129
    v_rcp_f32 v130, v130
    v_mfma_f32_32x32x16_bf16 v[80:95], a[196:199], v[100:103], v[80:95]
    ds_read_b128 v[124:127], v19 offset:32768
    buffer_load_dwordx4 v[196:199], v1, s[20:23], s37 offen offset:1024 sc1
    v_rcp_f32 v131, v131
    v_mfma_f32_32x32x16_bf16 v[64:79], a[72:75], v[104:107], v[64:79]
    s_add_u32 s37, s15, s13
    v_mul_f32 v132, v132, v128
    v_mul_f32 v133, v133, v129
    v_mul_f32 v134, v134, v130
    v_mul_f32 v135, v135, v131
    v_cvt_pk_bf16_f32 v156, v132, v133
    v_mfma_f32_32x32x16_bf16 v[80:95], a[200:203], v[104:107], v[80:95]
    buffer_load_dwordx4 v[200:203], v1, s[20:23], s37 offen offset:0 sc1
    v_cvt_pk_bf16_f32 v157, v134, v135
    v_mul_f32 v136, v52, v52
    v_mul_f32 v137, v53, v53
    v_mul_f32 v138, v54, v54
    v_mfma_f32_32x32x16_bf16 v[64:79], a[76:79], v[108:111], v[64:79]
    v_mul_f32 v139, v55, v55
    v_fma_f32 v136, v136, s62, v24
    v_fma_f32 v137, v137, s62, v24
    v_fma_f32 v138, v138, s62, v24
    v_fma_f32 v139, v139, s62, v24
    v_mul_f32 v136, v136, v52
    v_mfma_f32_32x32x16_bf16 v[80:95], a[204:207], v[108:111], v[80:95]
    buffer_load_dwordx4 v[204:207], v1, s[20:23], s37 offen offset:1024 sc1
    v_mul_f32 v137, v137, v53
    v_mul_f32 v138, v138, v54
    v_mul_f32 v139, v139, v55
    s_waitcnt lgkmcnt(0)
    v_mfma_f32_32x32x16_bf16 v[64:79], a[80:83], v[112:115], v[64:79]
    ds_read_b128 v[96:99], v12 offset:49152
    s_add_u32 s37, s15, s14
    v_exp_f32 v136, v136
    v_mul_f32 v140, v52, v60
    v_mfma_f32_32x32x16_bf16 v[80:95], a[208:211], v[112:115], v[80:95]
    ds_read_b128 v[100:103], v13 offset:49152
    buffer_load_dwordx4 v[208:211], v1, s[20:23], s37 offen offset:0 sc1
    v_exp_f32 v137, v137
    v_mfma_f32_32x32x16_bf16 v[64:79], a[84:87], v[116:119], v[64:79]
    ds_read_b128 v[104:107], v14 offset:49152
    v_mul_f32 v141, v53, v61
    v_exp_f32 v138, v138
    v_mul_f32 v142, v54, v62
    v_mfma_f32_32x32x16_bf16 v[80:95], a[212:215], v[116:119], v[80:95]
    ds_read_b128 v[108:111], v15 offset:49152
    buffer_load_dwordx4 v[212:215], v1, s[20:23], s37 offen offset:1024 sc1
    v_exp_f32 v139, v139
    v_mfma_f32_32x32x16_bf16 v[64:79], a[88:91], v[120:123], v[64:79]
    v_mul_f32 v143, v55, v63
    v_add_f32 v136, 1.0, v136
    v_add_f32 v137, 1.0, v137
    v_add_f32 v138, 1.0, v138
    v_add_f32 v139, 1.0, v139
    v_mfma_f32_32x32x16_bf16 v[80:95], a[216:219], v[120:123], v[80:95]
    v_rcp_f32 v136, v136
    v_rcp_f32 v137, v137
    v_rcp_f32 v138, v138
    v_mfma_f32_32x32x16_bf16 v[64:79], a[92:95], v[124:127], v[64:79]
    v_xor_b32 v12, 65536, v12
    v_rcp_f32 v139, v139
    v_mul_f32 v140, v140, v136
    v_mul_f32 v141, v141, v137
    v_mul_f32 v142, v142, v138
    v_mfma_f32_32x32x16_bf16 v[80:95], a[220:223], v[124:127], v[80:95]
    v_mul_f32 v143, v143, v139
    v_cvt_pk_bf16_f32 v158, v140, v141
    v_cvt_pk_bf16_f32 v159, v142, v143
    s_waitcnt lgkmcnt(0)
    v_mfma_f32_32x32x16_bf16 v[64:79], a[96:99], v[96:99], v[64:79]
    ds_read_b128 v[112:115], v16 offset:49152
    s_mul_i32 s53, s17, 229376
    s_add_u32 s53, s53, s34
    s_add_u32 s47, s53, 57344
    v_xor_b32 v13, 65536, v13
    v_mfma_f32_32x32x16_bf16 v[80:95], a[224:227], v[96:99], v[80:95]
    ds_read_b128 v[116:119], v17 offset:49152
    buffer_store_dwordx4 v[152:155], v1, s[20:23], s53 offen sc1
    v_mfma_f32_32x32x16_bf16 v[64:79], a[100:103], v[100:103], v[64:79]
    ds_read_b128 v[120:123], v18 offset:49152
    v_xor_b32 v14, 65536, v14
    v_mfma_f32_32x32x16_bf16 v[80:95], a[228:231], v[100:103], v[80:95]
    ds_read_b128 v[124:127], v19 offset:49152
    buffer_store_dwordx4 v[156:159], v1, s[20:23], s47 offen sc1
    v_mfma_f32_32x32x16_bf16 v[64:79], a[104:107], v[104:107], v[64:79]
    s_mul_i32 s15, s65, 14336
    s_add_u32 s15, s15, s32
    s_add_u32 s37, s15, s8
    v_xor_b32 v15, 65536, v15
    v_mfma_f32_32x32x16_bf16 v[80:95], a[232:235], v[104:107], v[80:95]
    buffer_load_dwordx4 v[216:219], v1, s[20:23], s37 offen offset:0 sc1
    v_mfma_f32_32x32x16_bf16 v[64:79], a[108:111], v[108:111], v[64:79]
    s_branch L_ld_m3
.p2align 12
L_st_m3:
L_wA_m3:
    s_branch L_retA
L_ld_m3:
    v_mfma_f32_32x32x16_bf16 v[80:95], a[236:239], v[108:111], v[80:95]
    s_waitcnt vmcnt(12) lgkmcnt(0)
    s_barrier
    v_mfma_f32_32x32x16_bf16 v[64:79], a[112:115], v[112:115], v[64:79]
    ds_read_b128 v[96:99], v12 offset:0
    buffer_load_dwordx4 v[220:223], v1, s[20:23], s37 offen offset:1024 sc1
    s_add_u32 s37, s15, s9
    v_xor_b32 v16, 65536, v16
    v_mfma_f32_32x32x16_bf16 v[80:95], a[240:243], v[112:115], v[80:95]
    ds_read_b128 v[100:103], v13 offset:0
    buffer_load_dwordx4 v[224:227], v1, s[20:23], s37 offen offset:0 sc1
    v_mfma_f32_32x32x16_bf16 v[64:79], a[116:119], v[116:119], v[64:79]
    ds_read_b128 v[104:107], v14 offset:0
    v_xor_b32 v17, 65536, v17
    v_mfma_f32_32x32x16_bf16 v[80:95], a[244:247], v[116:119], v[80:95]
    ds_read_b128 v[108:111], v15 offset:0
    buffer_load_dwordx4 v[228:231], v1, s[20:23], s37 offen offset:1024 sc1
    v_mfma_f32_32x32x16_bf16 v[64:79], a[120:123], v[120:123], v[64:79]
    v_xor_b32 v18, 65536, v18
    v_mfma_f32_32x32x16_bf16 v[80:95], a[248:251], v[120:123], v[80:95]
    s_add_u32 s37, s15, s10
    v_mfma_f32_32x32x16_bf16 v[64:79], a[124:127], v[124:127], v[64:79]
    buffer_load_dwordx4 v[232:235], v1, s[20:23], s37 offen offset:0 sc1
    v_xor_b32 v19, 65536, v19
    v_mfma_f32_32x32x16_bf16 v[80:95], a[252:255], v[124:127], v[80:95]
    s_waitcnt lgkmcnt(0)
    v_mfma_f32_32x32x16_bf16 v[32:47], a[0:3], v[96:99], 0
    ds_read_b128 v[112:115], v16 offset:0
    ds_read_b128 v[116:119], v17 offset:0
    buffer_load_dwordx4 v[236:239], v1, s[20:23], s37 offen offset:1024 sc1
    v_mfma_f32_32x32x16_bf16 v[32:47], a[4:7], v[100:103], v[32:47]
    ds_read_b128 v[120:123], v18 offset:0
    ds_read_b128 v[124:127], v19 offset:0
    s_add_u32 s37, s15, s11
    v_mfma_f32_32x32x16_bf16 v[32:47], a[8:11], v[104:107], v[32:47]
    buffer_load_dwordx4 v[240:243], v1, s[20:23], s37 offen offset:0 sc1
    v_mul_f32 v128, v64, v64
    v_mul_f32 v129, v65, v65
    v_mul_f32 v130, v66, v66
    v_mul_f32 v131, v67, v67
    v_mfma_f32_32x32x16_bf16 v[32:47], a[12:15], v[108:111], v[32:47]
    v_fma_f32 v128, v128, s62, v24
    v_fma_f32 v129, v129, s62, v24
    v_fma_f32 v130, v130, s62, v24
    v_fma_f32 v131, v131, s62, v24
    v_mul_f32 v128, v128, v64
    v_mul_f32 v129, v129, v65
    s_waitcnt lgkmcnt(2)
    v_mfma_f32_32x32x16_bf16 v[32:47], a[16:19], v[112:115], v[32:47]
    ds_read_b128 v[96:99], v12 offset:16384
    ds_read_b128 v[100:103], v13 offset:16384
    buffer_load_dwordx4 v[244:247], v1, s[20:23], s37 offen offset:1024 sc1
    v_mul_f32 v130, v130, v66
    v_mfma_f32_32x32x16_bf16 v[32:47], a[20:23], v[116:119], v[32:47]
    ds_read_b128 v[104:107], v14 offset:16384
    ds_read_b128 v[108:111], v15 offset:16384
    s_add_u32 s37, s15, s12
    v_mul_f32 v131, v131, v67
    v_exp_f32 v128, v128
    s_waitcnt lgkmcnt(4)
    v_mfma_f32_32x32x16_bf16 v[32:47], a[24:27], v[120:123], v[32:47]
    buffer_load_dwordx4 v[248:251], v1, s[20:23], s37 offen offset:0 sc1
    v_mul_f32 v132, v64, v72
    v_exp_f32 v129, v129
    v_mul_f32 v133, v65, v73
    v_mfma_f32_32x32x16_bf16 v[32:47], a[28:31], v[124:127], v[32:47]
    v_exp_f32 v130, v130
    v_mul_f32 v134, v66, v74
    v_exp_f32 v131, v131
    v_mul_f32 v135, v67, v75
    s_waitcnt lgkmcnt(2)
    v_mfma_f32_32x32x16_bf16 v[32:47], a[32:35], v[96:99], v[32:47]
    ds_read_b128 v[112:115], v16 offset:16384
    ds_read_b128 v[116:119], v17 offset:16384
    buffer_load_dwordx4 v[252:255], v1, s[20:23], s37 offen offset:1024 sc1
    v_add_f32 v128, 1.0, v128
    v_mfma_f32_32x32x16_bf16 v[32:47], a[36:39], v[100:103], v[32:47]
    ds_read_b128 v[120:123], v18 offset:16384
    ds_read_b128 v[124:127], v19 offset:16384
    v_add_f32 v129, 1.0, v129
    v_add_f32 v130, 1.0, v130
    v_add_f32 v131, 1.0, v131
    s_waitcnt lgkmcnt(4)
    v_mfma_f32_32x32x16_bf16 v[32:47], a[40:43], v[104:107], v[32:47]
    v_rcp_f32 v128, v128
    v_rcp_f32 v129, v129
    v_rcp_f32 v130, v130
    v_mfma_f32_32x32x16_bf16 v[32:47], a[44:47], v[108:111], v[32:47]
    v_rcp_f32 v131, v131
    v_mul_f32 v132, v132, v128
    v_mul_f32 v133, v133, v129
    v_mul_f32 v134, v134, v130
    v_mul_f32 v135, v135, v131
    s_waitcnt lgkmcnt(2)
    v_mfma_f32_32x32x16_bf16 v[32:47], a[48:51], v[112:115], v[32:47]
    ds_read_b128 v[96:99], v12 offset:32768
    ds_read_b128 v[100:103], v13 offset:32768
    v_cvt_pk_bf16_f32 v144, v132, v133
    v_cvt_pk_bf16_f32 v145, v134, v135
    v_mul_f32 v136, v68, v68
    v_mul_f32 v137, v69, v69
    v_mfma_f32_32x32x16_bf16 v[32:47], a[52:55], v[116:119], v[32:47]
    ds_read_b128 v[104:107], v14 offset:32768
    ds_read_b128 v[108:111], v15 offset:32768
    v_mul_f32 v138, v70, v70
    v_mul_f32 v139, v71, v71
    v_fma_f32 v136, v136, s62, v24
    v_fma_f32 v137, v137, s62, v24
    s_waitcnt lgkmcnt(4)
    v_mfma_f32_32x32x16_bf16 v[32:47], a[56:59], v[120:123], v[32:47]
    v_fma_f32 v138, v138, s62, v24
    v_fma_f32 v139, v139, s62, v24
    v_mul_f32 v136, v136, v68
    v_mul_f32 v137, v137, v69
    v_mul_f32 v138, v138, v70
    v_mul_f32 v139, v139, v71
    v_mfma_f32_32x32x16_bf16 v[32:47], a[60:63], v[124:127], v[32:47]
    v_exp_f32 v136, v136
    v_mul_f32 v140, v68, v76
    v_exp_f32 v137, v137
    v_mul_f32 v141, v69, v77
    s_waitcnt lgkmcnt(2)
    v_mfma_f32_32x32x16_bf16 v[32:47], a[64:67], v[96:99], v[32:47]
    ds_read_b128 v[112:115], v16 offset:32768
    ds_read_b128 v[116:119], v17 offset:32768
    v_exp_f32 v138, v138
    v_mul_f32 v142, v70, v78
    v_mfma_f32_32x32x16_bf16 v[32:47], a[68:71], v[100:103], v[32:47]
    ds_read_b128 v[120:123], v18 offset:32768
    ds_read_b128 v[124:127], v19 offset:32768
    v_exp_f32 v139, v139
    v_mul_f32 v143, v71, v79
    v_add_f32 v136, 1.0, v136
    s_waitcnt lgkmcnt(4)
    v_mfma_f32_32x32x16_bf16 v[32:47], a[72:75], v[104:107], v[32:47]
    v_add_f32 v137, 1.0, v137
    v_add_f32 v138, 1.0, v138
    v_add_f32 v139, 1.0, v139
    v_rcp_f32 v136, v136
    v_mfma_f32_32x32x16_bf16 v[32:47], a[76:79], v[108:111], v[32:47]
    v_rcp_f32 v137, v137
    v_rcp_f32 v138, v138
    v_rcp_f32 v139, v139
    s_waitcnt lgkmcnt(2)
    v_mfma_f32_32x32x16_bf16 v[32:47], a[80:83], v[112:115], v[32:47]
    ds_read_b128 v[96:99], v12 offset:49152
    ds_read_b128 v[100:103], v13 offset:49152
    v_mul_f32 v140, v140, v136
    v_mul_f32 v141, v141, v137
    v_mul_f32 v142, v142, v138
    v_mul_f32 v143, v143, v139
    v_mfma_f32_32x32x16_bf16 v[32:47], a[84:87], v[116:119], v[32:47]
    ds_read_b128 v[104:107], v14 offset:49152
    ds_read_b128 v[108:111], v15 offset:49152
    v_cvt_pk_bf16_f32 v146, v140, v141
    v_cvt_pk_bf16_f32 v147, v142, v143
    v_mul_f32 v128, v80, v80
    v_mul_f32 v129, v81, v81
    s_waitcnt lgkmcnt(4)
    v_mfma_f32_32x32x16_bf16 v[32:47], a[88:91], v[120:123], v[32:47]
    v_mul_f32 v130, v82, v82
    v_mul_f32 v131, v83, v83
    v_fma_f32 v128, v128, s62, v24
    v_fma_f32 v129, v129, s62, v24
    v_fma_f32 v130, v130, s62, v24
    v_fma_f32 v131, v131, s62, v24
    v_mfma_f32_32x32x16_bf16 v[32:47], a[92:95], v[124:127], v[32:47]
    s_add_u32 s39, s35, 3584
    s_waitcnt vmcnt(10)
    s_barrier
    s_waitcnt lgkmcnt(2)
    v_mfma_f32_32x32x16_bf16 v[32:47], a[96:99], v[96:99], v[32:47]
    ds_read_b128 v[112:115], v16 offset:49152
    ds_read_b128 v[116:119], v17 offset:49152
    buffer_store_dwordx2 v[6:7], v2, s[20:23], s39 offen sc1
    v_mul_f32 v128, v128, v80
    v_mfma_f32_32x32x16_bf16 v[32:47], a[100:103], v[100:103], v[32:47]
    ds_read_b128 v[120:123], v18 offset:49152
    ds_read_b128 v[124:127], v19 offset:49152
    s_mul_i32 s15, s65, 14336
    s_add_u32 s15, s15, s32
    s_add_u32 s37, s15, s13
    v_mul_f32 v129, v129, v81
    s_waitcnt lgkmcnt(4)
    v_mfma_f32_32x32x16_bf16 v[32:47], a[104:107], v[104:107], v[32:47]
    buffer_load_dwordx4 a[0:3], v1, s[20:23], s37 offen offset:0 sc1
    v_mul_f32 v130, v130, v82
    v_mul_f32 v131, v131, v83
    v_exp_f32 v128, v128
    v_mfma_f32_32x32x16_bf16 v[32:47], a[108:111], v[108:111], v[32:47]
    v_mul_f32 v132, v80, v88
    v_exp_f32 v129, v129
    v_mul_f32 v133, v81, v89
    v_exp_f32 v130, v130
    s_waitcnt lgkmcnt(2)
    v_mfma_f32_32x32x16_bf16 v[32:47], a[112:115], v[112:115], v[32:47]
    ds_read_b128 v[96:99], v12 offset:0
    ds_read_b128 v[100:103], v13 offset:0
    buffer_load_dwordx4 a[4:7], v1, s[20:23], s37 offen offset:1024 sc1
    v_mul_f32 v134, v82, v90
    v_mfma_f32_32x32x16_bf16 v[32:47], a[116:119], v[116:119], v[32:47]
    ds_read_b128 v[104:107], v14 offset:0
    ds_read_b128 v[108:111], v15 offset:0
    s_add_u32 s37, s15, s14
    v_exp_f32 v131, v131
    v_mul_f32 v135, v83, v91
    s_waitcnt lgkmcnt(4)
    v_mfma_f32_32x32x16_bf16 v[32:47], a[120:123], v[120:123], v[32:47]
    buffer_load_dwordx4 a[8:11], v1, s[20:23], s37 offen offset:0 sc1
    v_add_f32 v128, 1.0, v128
    v_add_f32 v129, 1.0, v129
    v_add_f32 v130, 1.0, v130
    v_add_f32 v131, 1.0, v131
    v_mfma_f32_32x32x16_bf16 v[32:47], a[124:127], v[124:127], v[32:47]
    v_rcp_f32 v128, v128
    v_rcp_f32 v129, v129
    v_rcp_f32 v130, v130
    s_waitcnt lgkmcnt(2)
    v_mfma_f32_32x32x16_bf16 v[48:63], a[128:131], v[96:99], 0
    ds_read_b128 v[112:115], v16 offset:0
    ds_read_b128 v[116:119], v17 offset:0
    buffer_load_dwordx4 a[12:15], v1, s[20:23], s37 offen offset:1024 sc1
    v_mfma_f32_32x32x16_bf16 v[48:63], a[132:135], v[100:103], v[48:63]
    ds_read_b128 v[120:123], v18 offset:0
    ds_read_b128 v[124:127], v19 offset:0
    s_mul_i32 s15, s66, 14336
    s_add_u32 s15, s15, s32
    s_add_u32 s37, s15, s8
    s_waitcnt lgkmcnt(4)
    v_mfma_f32_32x32x16_bf16 v[48:63], a[136:139], v[104:107], v[48:63]
    buffer_load_dwordx4 a[72:75], v1, s[20:23], s37 offen offset:0 sc1
    v_rcp_f32 v131, v131
    v_mul_f32 v132, v132, v128
    v_mul_f32 v133, v133, v129
    v_mfma_f32_32x32x16_bf16 v[48:63], a[140:143], v[108:111], v[48:63]
    v_mul_f32 v134, v134, v130
    v_mul_f32 v135, v135, v131
    v_cvt_pk_bf16_f32 v148, v132, v133
    v_cvt_pk_bf16_f32 v149, v134, v135
    v_mul_f32 v136, v84, v84
    v_mul_f32 v137, v85, v85
    s_waitcnt lgkmcnt(2)
    v_mfma_f32_32x32x16_bf16 v[48:63], a[144:147], v[112:115], v[48:63]
    ds_read_b128 v[96:99], v12 offset:16384
    ds_read_b128 v[100:103], v13 offset:16384
    buffer_load_dwordx4 a[76:79], v1, s[20:23], s37 offen offset:1024 sc1
    v_mul_f32 v138, v86, v86
    v_mfma_f32_32x32x16_bf16 v[48:63], a[148:151], v[116:119], v[48:63]
    ds_read_b128 v[104:107], v14 offset:16384
    ds_read_b128 v[108:111], v15 offset:16384
    v_mul_f32 v139, v87, v87
    v_fma_f32 v136, v136, s62, v24
    v_fma_f32 v137, v137, s62, v24
    v_fma_f32 v138, v138, s62, v24
    s_waitcnt lgkmcnt(4)
    v_mfma_f32_32x32x16_bf16 v[48:63], a[152:155], v[120:123], v[48:63]
    s_add_u32 s37, s15, s9
    v_fma_f32 v139, v139, s62, v24
    v_mul_f32 v136, v136, v84
    v_mul_f32 v137, v137, v85
    v_mul_f32 v138, v138, v86
    v_mul_f32 v139, v139, v87
    v_mfma_f32_32x32x16_bf16 v[48:63], a[156:159], v[124:127], v[48:63]
    buffer_load_dwordx4 a[80:83], v1, s[20:23], s37 offen offset:0 sc1
    v_exp_f32 v136, v136
    v_mul_f32 v140, v84, v92
    s_waitcnt lgkmcnt(2)
    v_mfma_f32_32x32x16_bf16 v[48:63], a[160:163], v[96:99], v[48:63]
    ds_read_b128 v[112:115], v16 offset:16384
    ds_read_b128 v[116:119], v17 offset:16384
    v_exp_f32 v137, v137
    v_mul_f32 v141, v85, v93
    v_mfma_f32_32x32x16_bf16 v[48:63], a[164:167], v[100:103], v[48:63]
    ds_read_b128 v[120:123], v18 offset:16384
    ds_read_b128 v[124:127], v19 offset:16384
    buffer_load_dwordx4 a[84:87], v1, s[20:23], s37 offen offset:1024 sc1
    s_waitcnt lgkmcnt(4)
    v_mfma_f32_32x32x16_bf16 v[48:63], a[168:171], v[104:107], v[48:63]
    s_mul_i32 s63, s64, 896
    s_add_u32 s63, s63, 0
    v_exp_f32 v138, v138
    v_mul_f32 v142, v86, v94
    v_mfma_f32_32x32x16_bf16 v[48:63], a[172:175], v[108:111], v[48:63]
    v_exp_f32 v139, v139
    v_mul_f32 v143, v87, v95
    v_add_f32 v136, 1.0, v136
    v_add_f32 v137, 1.0, v137
    v_add_f32 v138, 1.0, v138
    v_add_f32 v139, 1.0, v139
    v_rcp_f32 v136, v136
    v_rcp_f32 v137, v137
    v_rcp_f32 v138, v138
    v_rcp_f32 v139, v139
    v_mul_f32 v140, v140, v136
    v_mul_f32 v141, v141, v137
    v_mul_f32 v142, v142, v138
    v_mul_f32 v143, v143, v139
    v_cvt_pk_bf16_f32 v150, v140, v141
    v_cvt_pk_bf16_f32 v151, v142, v143
    s_waitcnt lgkmcnt(2)
    v_mfma_f32_32x32x16_bf16 v[48:63], a[176:179], v[112:115], v[48:63]
    ds_read_b128 v[96:99], v12 offset:32768
    ds_read_b128 v[100:103], v13 offset:32768
    buffer_load_dwordx2 v[30:31], v5, s[20:23], s63 offen sc1
    v_mul_f32 v128, v32, v32
    v_mfma_f32_32x32x16_bf16 v[48:63], a[180:183], v[116:119], v[48:63]
    ds_read_b128 v[104:107], v14 offset:32768
    ds_read_b128 v[108:111], v15 offset:32768
    s_mul_i32 s53, s18, 229376
    s_add_u32 s53, s53, s34
    s_add_u32 s47, s53, 57344
    v_mul_f32 v129, v33, v33
    s_waitcnt lgkmcnt(4)
    v_mfma_f32_32x32x16_bf16 v[48:63], a[184:187], v[120:123], v[48:63]
    buffer_store_dwordx4 v[144:147], v1, s[20:23], s53 offen sc1
    v_mul_f32 v130, v34, v34
    v_mul_f32 v131, v35, v35
    v_fma_f32 v128, v128, s62, v24
    v_fma_f32 v129, v129, s62, v24
    v_mfma_f32_32x32x16_bf16 v[48:63], a[188:191], v[124:127], v[48:63]
    v_fma_f32 v130, v130, s62, v24
    v_fma_f32 v131, v131, s62, v24
    v_mul_f32 v128, v128, v32
    v_mul_f32 v129, v129, v33
    v_mul_f32 v130, v130, v34
    v_mul_f32 v131, v131, v35
    s_waitcnt lgkmcnt(2)
    v_mfma_f32_32x32x16_bf16 v[48:63], a[192:195], v[96:99], v[48:63]
    ds_read_b128 v[112:115], v16 offset:32768
    ds_read_b128 v[116:119], v17 offset:32768
    buffer_store_dwordx4 v[148:151], v1, s[20:23], s47 offen sc1
    v_mfma_f32_32x32x16_bf16 v[48:63], a[196:199], v[100:103], v[48:63]
    ds_read_b128 v[120:123], v18 offset:32768
    ds_read_b128 v[124:127], v19 offset:32768
    s_mul_i32 s15, s66, 14336
    s_add_u32 s15, s15, s32
    s_add_u32 s37, s15, s10
    s_waitcnt lgkmcnt(4)
    v_mfma_f32_32x32x16_bf16 v[48:63], a[200:203], v[104:107], v[48:63]
    buffer_load_dwordx4 a[88:91], v1, s[20:23], s37 offen offset:0 sc1
    v_exp_f32 v128, v128
    v_mul_f32 v132, v32, v40
    v_mfma_f32_32x32x16_bf16 v[48:63], a[204:207], v[108:111], v[48:63]
    v_exp_f32 v129, v129
    v_mul_f32 v133, v33, v41
    v_exp_f32 v130, v130
    v_mul_f32 v134, v34, v42
    s_waitcnt lgkmcnt(2)
    v_mfma_f32_32x32x16_bf16 v[48:63], a[208:211], v[112:115], v[48:63]
    ds_read_b128 v[96:99], v12 offset:49152
    ds_read_b128 v[100:103], v13 offset:49152
    buffer_load_dwordx4 a[92:95], v1, s[20:23], s37 offen offset:1024 sc1
    v_mfma_f32_32x32x16_bf16 v[48:63], a[212:215], v[116:119], v[48:63]
    ds_read_b128 v[104:107], v14 offset:49152
    ds_read_b128 v[108:111], v15 offset:49152
    s_add_u32 s37, s15, s11
    v_exp_f32 v131, v131
    v_mul_f32 v135, v35, v43
    s_waitcnt lgkmcnt(4)
    v_mfma_f32_32x32x16_bf16 v[48:63], a[216:219], v[120:123], v[48:63]
    buffer_load_dwordx4 a[96:99], v1, s[20:23], s37 offen offset:0 sc1
    v_add_f32 v128, 1.0, v128
    v_add_f32 v129, 1.0, v129
    v_add_f32 v130, 1.0, v130
    v_add_f32 v131, 1.0, v131
    v_mfma_f32_32x32x16_bf16 v[48:63], a[220:223], v[124:127], v[48:63]
    v_rcp_f32 v128, v128
    v_rcp_f32 v129, v129
    v_rcp_f32 v130, v130
    s_waitcnt lgkmcnt(2)
    v_mfma_f32_32x32x16_bf16 v[48:63], a[224:227], v[96:99], v[48:63]
    ds_read_b128 v[112:115], v16 offset:49152
    ds_read_b128 v[116:119], v17 offset:49152
    v_rcp_f32 v131, v131
    v_mul_f32 v132, v132, v128
    v_mul_f32 v133, v133, v129
    v_mfma_f32_32x32x16_bf16 v[48:63], a[228:231], v[100:103], v[48:63]
    ds_read_b128 v[120:123], v18 offset:49152
    ds_read_b128 v[124:127], v19 offset:49152
    buffer_load_dwordx4 a[100:103], v1, s[20:23], s37 offen offset:1024 sc1
    v_mul_f32 v134, v134, v130
    s_waitcnt lgkmcnt(4)
    v_mfma_f32_32x32x16_bf16 v[48:63], a[232:235], v[104:107], v[48:63]
    s_add_u32 s37, s15, s12
    v_mul_f32 v135, v135, v131
    v_cvt_pk_bf16_f32 v152, v132, v133
    v_cvt_pk_bf16_f32 v153, v134, v135
    v_mul_f32 v136, v36, v36
    v_mul_f32 v137, v37, v37
    v_mfma_f32_32x32x16_bf16 v[48:63], a[236:239], v[108:111], v[48:63]
    buffer_load_dwordx4 a[104:107], v1, s[20:23], s37 offen offset:0 sc1
    v_mul_f32 v138, v38, v38
    v_mul_f32 v139, v39, v39
    v_fma_f32 v136, v136, s62, v24
    v_fma_f32 v137, v137, s62, v24
    s_waitcnt lgkmcnt(2)
    v_mfma_f32_32x32x16_bf16 v[48:63], a[240:243], v[112:115], v[48:63]
    v_fma_f32 v138, v138, s62, v24
    v_fma_f32 v139, v139, s62, v24
    v_mul_f32 v136, v136, v36
    v_mul_f32 v137, v137, v37
    v_mul_f32 v138, v138, v38
    v_mul_f32 v139, v139, v39
    v_mfma_f32_32x32x16_bf16 v[48:63], a[244:247], v[116:119], v[48:63]
    buffer_load_dwordx4 a[108:111], v1, s[20:23], s37 offen offset:1024 sc1
    v_exp_f32 v136, v136
    v_mul_f32 v140, v36, v44
    s_waitcnt lgkmcnt(0)
    v_mfma_f32_32x32x16_bf16 v[48:63], a[248:251], v[120:123], v[48:63]
    s_add_u32 s37, s15, s13
    v_exp_f32 v137, v137
    v_mul_f32 v141, v37, v45
    v_exp_f32 v138, v138
    v_mfma_f32_32x32x16_bf16 v[48:63], a[252:255], v[124:127], v[48:63]
    buffer_load_dwordx4 a[112:115], v1, s[20:23], s37 offen offset:0 sc1
    buffer_load_dwordx4 a[116:119], v1, s[20:23], s37 offen offset:1024 sc1
    v_mul_f32 v142, v38, v46
    v_exp_f32 v139, v139
    v_mul_f32 v143, v39, v47
    v_add_f32 v136, 1.0, v136
    v_add_f32 v137, 1.0, v137
    v_add_f32 v138, 1.0, v138
    v_add_f32 v139, 1.0, v139
    v_rcp_f32 v136, v136
    v_rcp_f32 v137, v137
    v_rcp_f32 v138, v138
    v_rcp_f32 v139, v139
    v_mul_f32 v140, v140, v136
    v_mul_f32 v141, v141, v137
    v_mul_f32 v142, v142, v138
    v_mul_f32 v143, v143, v139
    v_cvt_pk_bf16_f32 v154, v140, v141
    v_cvt_pk_bf16_f32 v155, v142, v143
    v_mul_f32 v128, v48, v48
    v_mul_f32 v129, v49, v49
    v_mul_f32 v130, v50, v50
    v_mul_f32 v131, v51, v51
    v_fma_f32 v128, v128, s62, v24
    v_fma_f32 v129, v129, s62, v24
    v_fma_f32 v130, v130, s62, v24
    v_fma_f32 v131, v131, s62, v24
    s_waitcnt vmcnt(10)
    v_cmp_ne_u64 vcc, s[40:41], v[30:31]
    s_nop 0
    s_and_b32 s68, vcc_lo, 3
    s_cbranch_scc1 L_pr2
L_pd2:
    s_barrier
    s_mul_i32 s51, s64, 14336
    s_add_u32 s51, s51, s33
    s_add_u32 s55, s51, s8
    buffer_load_dwordx4 a[16:19], v1, s[20:23], s55 offen offset:0 sc1
    v_mul_f32 v128, v128, v48
    v_mul_f32 v129, v129, v49
    v_mul_f32 v130, v130, v50
    v_mul_f32 v131, v131, v51
    v_exp_f32 v128, v128
    buffer_load_dwordx4 a[20:23], v1, s[20:23], s55 offen offset:1024 sc1
    v_mul_f32 v132, v48, v56
    v_exp_f32 v129, v129
    v_mul_f32 v133, v49, v57
    v_exp_f32 v130, v130
    v_mul_f32 v134, v50, v58
    s_add_u32 s55, s51, s9
    buffer_load_dwordx4 a[24:27], v1, s[20:23], s55 offen offset:0 sc1
    v_exp_f32 v131, v131
    v_mul_f32 v135, v51, v59
    v_add_f32 v128, 1.0, v128
    v_add_f32 v129, 1.0, v129
    v_add_f32 v130, 1.0, v130
    buffer_load_dwordx4 a[28:31], v1, s[20:23], s55 offen offset:1024 sc1
    v_add_f32 v131, 1.0, v131
    v_rcp_f32 v128, v128
    v_rcp_f32 v129, v129
    v_rcp_f32 v130, v130
    v_rcp_f32 v131, v131
    s_add_u32 s55, s51, s10
    buffer_load_dwordx4 a[32:35], v1, s[20:23], s55 offen offset:0 sc1
    v_mul_f32 v132, v132, v128
    v_mul_f32 v133, v133, v129
    v_mul_f32 v134, v134, v130
    v_mul_f32 v135, v135, v131
    v_cvt_pk_bf16_f32 v156, v132, v133
    buffer_load_dwordx4 a[36:39], v1, s[20:23], s55 offen offset:1024 sc1
    v_cvt_pk_bf16_f32 v157, v134, v135
    v_mul_f32 v136, v52, v52
    v_mul_f32 v137, v53, v53
    v_mul_f32 v138, v54, v54
    v_mul_f32 v139, v55, v55
    s_mul_i32 s63, s65, 896
    s_add_u32 s63, s63, 3584
    buffer_load_dwordx2 v[30:31], v5, s[20:23], s63 offen sc1
    v_fma_f32 v136, v136, s62, v24
    v_fma_f32 v137, v137, s62, v24
    v_fma_f32 v138, v138, s62, v24
    v_fma_f32 v139, v139, s62, v24
    v_mul_f32 v136, v136, v52
    s_add_u32 s55, s51, s11
    buffer_load_dwordx4 a[40:43], v1, s[20:23], s55 offen offset:0 sc1
    v_mul_f32 v137, v137, v53
    v_mul_f32 v138, v138, v54
    v_mul_f32 v139, v139, v55
    v_exp_f32 v136, v136
    v_mul_f32 v140, v52, v60
    buffer_load_dwordx4 a[44:47], v1, s[20:23], s55 offen offset:1024 sc1
    v_exp_f32 v137, v137
    v_mul_f32 v141, v53, v61
    v_exp_f32 v138, v138
    v_mul_f32 v142, v54, v62
    v_exp_f32 v139, v139
    s_add_u32 s55, s51, s12
    buffer_load_dwordx4 a[48:51], v1, s[20:23], s55 offen offset:0 sc1
    v_mul_f32 v143, v55, v63
    v_add_f32 v136, 1.0, v136
    v_add_f32 v137, 1.0, v137
    v_add_f32 v138, 1.0, v138
    v_add_f32 v139, 1.0, v139
    buffer_load_dwordx4 a[52:55], v1, s[20:23], s55 offen offset:1024 sc1
    v_rcp_f32 v136, v136
    v_rcp_f32 v137, v137
    v_rcp_f32 v138, v138
    v_rcp_f32 v139, v139
    v_mul_f32 v140, v140, v136
    s_add_u32 s39, s35, 7168
    s_waitcnt vmcnt(19)
    s_barrier
    buffer_store_dwordx2 v[6:7], v2, s[20:23], s39 offen sc1
    v_mul_f32 v141, v141, v137
    v_mul_f32 v142, v142, v138
    v_mul_f32 v143, v143, v139
    v_cvt_pk_bf16_f32 v158, v140, v141
    v_cvt_pk_bf16_f32 v159, v142, v143
    s_add_u32 s55, s51, s13
    buffer_load_dwordx4 a[56:59], v1, s[20:23], s55 offen offset:0 sc1
    buffer_load_dwordx4 a[60:63], v1, s[20:23], s55 offen offset:1024 sc1
    s_add_u32 s55, s51, s14
    buffer_load_dwordx4 a[64:67], v1, s[20:23], s55 offen offset:0 sc1
    buffer_load_dwordx4 a[68:71], v1, s[20:23], s55 offen offset:1024 sc1
    s_mul_i32 s53, s19, 229376
    s_add_u32 s53, s53, s34
    s_add_u32 s47, s53, 57344
    buffer_store_dwordx4 v[152:155], v1, s[20:23], s53 offen sc1
    buffer_store_dwordx4 v[156:159], v1, s[20:23], s47 offen sc1
L_g2:
    s_waitcnt vmcnt(17)
    v_mfma_f32_32x32x16_bf16 v[64:79], v[160:163], a[16:19], 0
    s_mul_i32 s15, s66, 14336
    s_add_u32 s15, s15, s32
    s_add_u32 s37, s15, s14
    buffer_load_dwordx4 a[120:123], v1, s[20:23], s37 offen offset:0 sc1
    v_and_b32 v8, 31, v0
    v_mfma_f32_32x32x16_bf16 v[80:95], v[164:167], a[16:19], 0
    s_waitcnt vmcnt(12)
    v_cmp_ne_u64 vcc, s[40:41], v[30:31]
    s_nop 0
    s_and_b32 s68, vcc_lo, 3
    s_cbranch_scc1 L_pr3
L_pd3:
    s_barrier
    v_lshl_add_u32 v8, v8, 8, s56
    v_mfma_f32_32x32x16_bf16 v[96:111], v[160:163], a[20:23], 0
    s_mul_i32 s51, s65, 14336
    s_add_u32 s51, s51, s33
    s_add_u32 s55, s51, s8
    buffer_load_dwordx4 a[184:187], v1, s[20:23], s55 offen offset:0 sc1
    v_lshrrev_b32 v9, 5, v0
    v_mfma_f32_32x32x16_bf16 v[112:127], v[164:167], a[20:23], 0
    buffer_load_dwordx4 a[188:191], v1, s[20:23], s55 offen offset:1024 sc1
    s_add_u32 s55, s51, s9
    v_and_b32 v10, 15, v0
    v_xor_b32 v9, v9, v10
    v_lshl_add_u32 v12, v9, 4, v8
    v_mfma_f32_32x32x16_bf16 v[64:79], v[168:171], a[24:27], v[64:79]
    buffer_load_dwordx4 a[192:195], v1, s[20:23], s55 offen offset:0 sc1
    v_xor_b32 v13, 32, v12
    v_xor_b32 v14, 64, v12
    v_xor_b32 v15, 96, v12
    v_xor_b32 v16, 128, v12
    v_mfma_f32_32x32x16_bf16 v[80:95], v[172:175], a[24:27], v[80:95]
    v_xor_b32 v17, 160, v12
    v_xor_b32 v18, 192, v12
    v_xor_b32 v19, 224, v12
    s_lshl_b32 s59, s42, 10
    s_add_u32 s59, s59, 16384
    v_lshl_add_u32 v28, v0, 7, s59
    v_mfma_f32_32x32x16_bf16 v[96:111], v[168:171], a[28:31], v[96:111]
    buffer_load_dwordx4 a[196:199], v1, s[20:23], s55 offen offset:1024 sc1
    s_add_u32 s55, s51, s10
    v_and_b32 v56, 31, v0
    s_lshl_b32 s60, s44, 5
    v_add_u32 v56, s60, v56
    v_mfma_f32_32x32x16_bf16 v[112:127], v[172:175], a[28:31], v[112:127]
    buffer_load_dwordx4 a[200:203], v1, s[20:23], s55 offen offset:0 sc1
    v_lshrrev_b32 v9, 3, v0
    v_lshl_add_u32 v28, v9, 28, v28
    v_cvt_f32_u32 v56, v56
    v_mul_f32 v56, 0x3b000000, v56
    v_mfma_f32_32x32x16_bf16 v[64:79], v[176:179], a[32:35], v[64:79]
    v_and_b32 v11, 31, v0
    v_and_b32 v10, 16, v0
    v_lshrrev_b32 v57, 5, v0
    s_lshl_b32 s60, s48, 7
    s_add_u32 s60, s60, s49
    v_lshl_add_u32 v57, v57, 3, s60
    v_mfma_f32_32x32x16_bf16 v[80:95], v[180:183], a[32:35], v[80:95]
    buffer_load_dwordx4 a[204:207], v1, s[20:23], s55 offen offset:1024 sc1
    s_add_u32 s55, s51, s11
    v_add_u32 v11, v11, v10
    v_lshlrev_b32 v11, 2, v11
    v_lshrrev_b32 v9, 5, v0
    v_mfma_f32_32x32x16_bf16 v[96:111], v[176:179], a[36:39], v[96:111]
    buffer_load_dwordx4 a[208:211], v1, s[20:23], s55 offen offset:0 sc1
    v_bfe_u32 v10, v0, 2, 2
    v_lshl_add_u32 v9, v9, 2, v10
    v_and_b32 v58, 1, v0
    v_cvt_f32_u32 v58, v58
    v_mfma_f32_32x32x16_bf16 v[112:127], v[180:183], a[36:39], v[112:127]
    v_mul_u32_u24 v29, 136, v9
    v_bfe_u32 v9, v0, 4, 1
    v_fma_f32 v58, v58, -2.0, 1.0
    v_min_u32 v59, 1, v57
    v_cvt_f32_u32 v59, v59
    v_cvt_f32_u32 v57, v57
    s_waitcnt vmcnt(18)
    v_mfma_f32_32x32x16_bf16 v[64:79], v[184:187], a[40:43], v[64:79]
    v_lshl_add_u32 v29, v9, 5, v29
    v_and_b32 v9, 3, v0
    v_fma_f32 v58, -v59, v58, v58
    v_mul_f32 v57, v57, v56
    v_mul_f32 v59, 0x42000000, v56
    v_lshl_add_u32 v29, v9, 3, v29
    v_mfma_f32_32x32x16_bf16 v[80:95], v[188:191], a[40:43], v[80:95]
    v_add_u32 v29, 147456, v29
    v_cos_f32 v59, v59
    v_fmamk_f32 v48, v56, 0x00000000, v57
    v_fmamk_f32 v49, v56, 0x40000000, v57
    v_fmamk_f32 v50, v56, 0x40800000, v57
    s_waitcnt vmcnt(17)
    v_mfma_f32_32x32x16_bf16 v[96:111], v[184:187], a[44:47], v[96:111]
    s_add_u32 s39, s39, 3584
    s_waitcnt vmcnt(8)
    s_barrier
    buffer_store_dwordx2 v[6:7], v2, s[20:23], s39 offen sc1
    v_fmamk_f32 v51, v56, 0x40c00000, v57
    v_mfma_f32_32x32x16_bf16 v[112:127], v[188:191], a[44:47], v[112:127]
    buffer_load_dwordx4 a[212:215], v1, s[20:23], s55 offen offset:1024 sc1
    v_cos_f32 v32, v48
    v_sin_f32 v40, v48
    v_mfma_f32_32x32x16_bf16 v[64:79], v[192:195], a[48:51], v[64:79]
    s_mul_i32 s63, s66, 896
    s_add_u32 s63, s63, 7168
    v_cos_f32 v33, v49
    v_sin_f32 v41, v49
    v_mfma_f32_32x32x16_bf16 v[80:95], v[196:199], a[48:51], v[80:95]
    buffer_load_dwordx2 v[30:31], v5, s[20:23], s63 offen sc1
    s_add_u32 s55, s51, s12
    v_cos_f32 v34, v50
    v_mfma_f32_32x32x16_bf16 v[96:111], v[192:195], a[52:55], v[96:111]
    buffer_load_dwordx4 a[216:219], v1, s[20:23], s55 offen offset:0 sc1
    v_sin_f32 v42, v50
    v_cos_f32 v35, v51
    v_mfma_f32_32x32x16_bf16 v[112:127], v[196:199], a[52:55], v[112:127]
    v_sin_f32 v43, v51
    v_fmamk_f32 v48, v56, 0x42000000, v57
    v_fmamk_f32 v49, v56, 0x42080000, v57
    v_fmamk_f32 v50, v56, 0x42100000, v57
    v_fmamk_f32 v51, v56, 0x42180000, v57
    v_mfma_f32_32x32x16_bf16 v[64:79], v[200:203], a[56:59], v[64:79]
    buffer_load_dwordx4 a[220:223], v1, s[20:23], s55 offen offset:1024 sc1
    s_add_u32 s55, s51, s13
    v_cos_f32 v36, v48
    v_mfma_f32_32x32x16_bf16 v[80:95], v[204:207], a[56:59], v[80:95]
    buffer_load_dwordx4 a[224:227], v1, s[20:23], s55 offen offset:0 sc1
    v_sin_f32 v44, v48
    v_cos_f32 v37, v49
    v_mfma_f32_32x32x16_bf16 v[96:111], v[200:203], a[60:63], v[96:111]
    v_sin_f32 v45, v49
    v_cos_f32 v38, v50
    v_sin_f32 v46, v50
    v_mfma_f32_32x32x16_bf16 v[112:127], v[204:207], a[60:63], v[112:127]
    buffer_load_dwordx4 a[228:231], v1, s[20:23], s55 offen offset:1024 sc1
    s_add_u32 s55, s51, s14
    v_cos_f32 v39, v51
    v_mfma_f32_32x32x16_bf16 v[64:79], v[208:211], a[64:67], v[64:79]
    buffer_load_dwordx4 a[232:235], v1, s[20:23], s55 offen offset:0 sc1
    v_sin_f32 v47, v51
    v_add_f32 v59, v59, v59
    v_add_f32 v52, v40, v58
    v_mfma_f32_32x32x16_bf16 v[80:95], v[212:215], a[64:67], v[80:95]
    v_cvt_pk_bf16_f32 v128, v32, v33
    v_cvt_pk_bf16_f32 v129, v34, v35
    v_cvt_pk_bf16_f32 v136, v52, v41
    v_cvt_pk_bf16_f32 v137, v42, v43
    s_branch L_ld_m4
.p2align 12
L_st_m4:
L_wA_m4:
    s_branch L_retA
L_wQ_m4:
    s_branch L_retQ
L_ld_m4:
    v_cvt_pk_bf16_f32 v132, v36, v37
    v_cvt_pk_bf16_f32 v133, v38, v39
    v_mfma_f32_32x32x16_bf16 v[96:111], v[208:211], a[68:71], v[96:111]
    buffer_load_dwordx4 a[236:239], v1, s[20:23], s55 offen offset:1024 sc1
    v_cvt_pk_bf16_f32 v140, v44, v45
    v_cvt_pk_bf16_f32 v141, v46, v47
    v_fma_f32 v32, v59, v36, -v32
    v_fma_f32 v33, v59, v37, -v33
    v_mfma_f32_32x32x16_bf16 v[112:127], v[212:215], a[68:71], v[112:127]
    buffer_load_dwordx4 a[124:127], v1, s[20:23], s37 offen offset:1024 sc1
    v_fma_f32 v34, v59, v38, -v34
    v_fma_f32 v35, v59, v39, -v35
    v_fma_f32 v40, v59, v44, -v40
    v_fma_f32 v41, v59, v45, -v41
    s_waitcnt vmcnt(16)
    v_mfma_f32_32x32x16_bf16 v[64:79], v[216:219], a[184:187], v[64:79]
    s_mul_i32 s15, s67, 14336
    s_add_u32 s15, s15, s32
    s_add_u32 s37, s15, s8
    v_fma_f32 v42, v59, v46, -v42
    v_fma_f32 v43, v59, v47, -v43
    v_cvt_pk_bf16_f32 v144, v32, v33
    v_mfma_f32_32x32x16_bf16 v[80:95], v[220:223], a[184:187], v[80:95]
    buffer_load_dwordx4 a[128:131], v1, s[20:23], s37 offen offset:0 sc1
    v_cvt_pk_bf16_f32 v145, v34, v35
    v_cvt_pk_bf16_f32 v152, v40, v41
    v_cvt_pk_bf16_f32 v153, v42, v43
    v_fma_f32 v36, v59, v32, -v36
    s_waitcnt vmcnt(16)
    v_mfma_f32_32x32x16_bf16 v[96:111], v[216:219], a[188:191], v[96:111]
    buffer_load_dwordx4 a[132:135], v1, s[20:23], s37 offen offset:1024 sc1
    v_fma_f32 v37, v59, v33, -v37
    v_fma_f32 v38, v59, v34, -v38
    v_fma_f32 v39, v59, v35, -v39
    v_fma_f32 v44, v59, v40, -v44
    v_mfma_f32_32x32x16_bf16 v[112:127], v[220:223], a[188:191], v[112:127]
    s_waitcnt vmcnt(9)
    v_cmp_ne_u64 vcc, s[40:41], v[30:31]
    s_nop 0
    s_and_b32 s68, vcc_lo, 3
    s_cbranch_scc1 L_pr4
L_pd4:
    s_barrier
    v_fma_f32 v45, v59, v41, -v45
    v_mfma_f32_32x32x16_bf16 v[64:79], v[224:227], a[192:195], v[64:79]
    s_mul_i32 s51, s66, 14336
    s_add_u32 s51, s51, s33
    s_add_u32 s55, s51, s8
    buffer_load_dwordx4 v[160:163], v1, s[20:23], s55 offen offset:0 sc1
    v_fma_f32 v46, v59, v42, -v46
    v_mfma_f32_32x32x16_bf16 v[80:95], v[228:231], a[192:195], v[80:95]
    buffer_load_dwordx4 v[164:167], v1, s[20:23], s55 offen offset:1024 sc1
    v_fma_f32 v47, v59, v43, -v47
    v_cvt_pk_bf16_f32 v148, v36, v37
    v_cvt_pk_bf16_f32 v149, v38, v39
    v_cvt_pk_bf16_f32 v156, v44, v45
    v_mfma_f32_32x32x16_bf16 v[96:111], v[224:227], a[196:199], v[96:111]
    s_add_u32 s55, s51, s9
    v_cvt_pk_bf16_f32 v157, v46, v47
    v_fmamk_f32 v48, v56, 0x41800000, v57
    v_fmamk_f32 v49, v56, 0x41900000, v57
    v_fmamk_f32 v50, v56, 0x41a00000, v57
    v_fmamk_f32 v51, v56, 0x41b00000, v57
    v_mfma_f32_32x32x16_bf16 v[112:127], v[228:231], a[196:199], v[112:127]
    buffer_load_dwordx4 v[168:171], v1, s[20:23], s55 offen offset:0 sc1
    v_cos_f32 v32, v48
    v_sin_f32 v40, v48
    v_mfma_f32_32x32x16_bf16 v[64:79], v[232:235], a[200:203], v[64:79]
    buffer_load_dwordx4 v[172:175], v1, s[20:23], s55 offen offset:1024 sc1
    v_cos_f32 v33, v49
    v_sin_f32 v41, v49
    v_mfma_f32_32x32x16_bf16 v[80:95], v[236:239], a[200:203], v[80:95]
    s_add_u32 s55, s51, s10
    v_cos_f32 v34, v50
    v_sin_f32 v42, v50
    v_mfma_f32_32x32x16_bf16 v[96:111], v[232:235], a[204:207], v[96:111]
    buffer_load_dwordx4 v[176:179], v1, s[20:23], s55 offen offset:0 sc1
    v_cos_f32 v35, v51
    v_sin_f32 v43, v51
    v_mfma_f32_32x32x16_bf16 v[112:127], v[236:239], a[204:207], v[112:127]
    buffer_load_dwordx2 v[30:31], v28, s[20:23], 0 offen sc1
    v_fmamk_f32 v48, v56, 0x42400000, v57
    v_fmamk_f32 v49, v56, 0x42480000, v57
    v_fmamk_f32 v50, v56, 0x42500000, v57
    v_fmamk_f32 v51, v56, 0x42580000, v57
    v_mfma_f32_32x32x16_bf16 v[64:79], v[240:243], a[208:211], v[64:79]
    v_cos_f32 v36, v48
    v_sin_f32 v44, v48
    v_cos_f32 v37, v49
    v_mfma_f32_32x32x16_bf16 v[80:95], v[244:247], a[208:211], v[80:95]
    buffer_load_dwordx4 v[180:183], v1, s[20:23], s55 offen offset:1024 sc1
    s_add_u32 s55, s51, s11
    v_sin_f32 v45, v49
    v_mfma_f32_32x32x16_bf16 v[96:111], v[240:243], a[212:215], v[96:111]
    buffer_load_dwordx4 v[184:187], v1, s[20:23], s55 offen offset:0 sc1
    v_cos_f32 v38, v50
    v_sin_f32 v46, v50
    v_mfma_f32_32x32x16_bf16 v[112:127], v[244:247], a[212:215], v[112:127]
    v_cos_f32 v39, v51
    v_sin_f32 v47, v51
    v_cvt_pk_bf16_f32 v130, v32, v33
    v_cvt_pk_bf16_f32 v131, v34, v35
    s_waitcnt vmcnt(16)
    v_mfma_f32_32x32x16_bf16 v[64:79], v[248:251], a[216:219], v[64:79]
    buffer_load_dwordx4 v[188:191], v1, s[20:23], s55 offen offset:1024 sc1
    s_add_u32 s55, s51, s12
    v_cvt_pk_bf16_f32 v138, v40, v41
    v_cvt_pk_bf16_f32 v139, v42, v43
    v_cvt_pk_bf16_f32 v134, v36, v37
    v_mfma_f32_32x32x16_bf16 v[80:95], v[252:255], a[216:219], v[80:95]
    buffer_load_dwordx4 v[192:195], v1, s[20:23], s55 offen offset:0 sc1
    v_cvt_pk_bf16_f32 v135, v38, v39
    v_cvt_pk_bf16_f32 v142, v44, v45
    v_cvt_pk_bf16_f32 v143, v46, v47
    v_fma_f32 v32, v59, v36, -v32
    s_waitcnt vmcnt(17)
    v_mfma_f32_32x32x16_bf16 v[96:111], v[248:251], a[220:223], v[96:111]
    v_fma_f32 v33, v59, v37, -v33
    v_fma_f32 v34, v59, v38, -v34
    v_fma_f32 v35, v59, v39, -v35
    v_fma_f32 v40, v59, v44, -v40
    v_fma_f32 v41, v59, v45, -v41
    v_fma_f32 v42, v59, v46, -v42
    v_mfma_f32_32x32x16_bf16 v[112:127], v[252:255], a[220:223], v[112:127]
    buffer_load_dwordx4 v[196:199], v1, s[20:23], s55 offen offset:1024 sc1
    s_add_u32 s55, s51, s13
    v_fma_f32 v43, v59, v47, -v43
    v_cvt_pk_bf16_f32 v146, v32, v33
    v_cvt_pk_bf16_f32 v147, v34, v35
    s_waitcnt vmcnt(17)
    v_mfma_f32_32x32x16_bf16 v[64:79], a[0:3], a[224:227], v[64:79]
    buffer_load_dwordx4 v[200:203], v1, s[20:23], s55 offen offset:0 sc1
    v_cvt_pk_bf16_f32 v154, v40, v41
    v_cvt_pk_bf16_f32 v155, v42, v43
    v_fma_f32 v36, v59, v32, -v36
    v_fma_f32 v37, v59, v33, -v37
    v_mfma_f32_32x32x16_bf16 v[80:95], a[4:7], a[224:227], v[80:95]
    v_fma_f32 v38, v59, v34, -v38
    v_fma_f32 v39, v59, v35, -v39
    v_fma_f32 v44, v59, v40, -v44
    v_fma_f32 v45, v59, v41, -v45
    v_fma_f32 v46, v59, v42, -v46
    v_fma_f32 v47, v59, v43, -v47
    s_waitcnt vmcnt(17)
    v_mfma_f32_32x32x16_bf16 v[96:111], a[0:3], a[228:231], v[96:111]
    buffer_load_dwordx4 v[204:207], v1, s[20:23], s55 offen offset:1024 sc1
    s_add_u32 s55, s51, s14
    v_cvt_pk_bf16_f32 v150, v36, v37
    v_cvt_pk_bf16_f32 v151, v38, v39
    v_cvt_pk_bf16_f32 v158, v44, v45
    v_mfma_f32_32x32x16_bf16 v[112:127], a[4:7], a[228:231], v[112:127]
    buffer_load_dwordx4 v[208:211], v1, s[20:23], s55 offen offset:0 sc1
    v_cvt_pk_bf16_f32 v159, v46, v47
    s_waitcnt vmcnt(18)
    v_mfma_f32_32x32x16_bf16 v[64:79], a[8:11], a[232:235], v[64:79]
    v_mfma_f32_32x32x16_bf16 v[80:95], a[12:15], a[232:235], v[80:95]
    buffer_load_dwordx4 v[212:215], v1, s[20:23], s55 offen offset:1024 sc1
    s_waitcnt vmcnt(18)
    v_mfma_f32_32x32x16_bf16 v[96:111], a[8:11], a[236:239], v[96:111]
    s_waitcnt vmcnt(9)
    v_cmp_ne_u64 vcc, s[40:41], v[30:31]
    s_nop 0
    s_and_b32 s68, vcc_lo, 255
    s_cbranch_scc1 L_pr5
L_pd5:
    s_barrier
    v_mfma_f32_32x32x16_bf16 v[112:127], a[12:15], a[236:239], v[112:127]
    s_lshl_b32 s53, s57, 16
    s_add_u32 s53, s53, 3145728
    s_mov_b32 s47, 0
    s_and_b32 s47, s47, 6144
    s_add_u32 s58, s47, s56
    v_mfma_f32_32x32x16_bf16 v[64:79], a[72:75], v[160:163], v[64:79]
    ds_read_b64_tr_b16 a[16:17], v29 offset:0
    s_mov_b32 m0, s58
    s_add_u32 s58, s58, s53
    buffer_load_dwordx4 v1, s[20:23], s58 offen offset:0 sc1 lds
    v_mfma_f32_32x32x16_bf16 v[80:95], a[76:79], v[160:163], v[80:95]
    ds_read_b64_tr_b16 a[18:19], v29 offset:1088
    ds_read_b64_tr_b16 a[20:21], v29 offset:64
    buffer_load_dwordx4 v1, s[20:23], s58 offen offset:1024 sc1 lds
    v_mfma_f32_32x32x16_bf16 v[96:111], a[72:75], v[164:167], v[96:111]
    ds_read_b64_tr_b16 a[22:23], v29 offset:1152
    s_add_u32 s47, s47, 2048
    s_and_b32 s47, s47, 6144
    s_add_u32 s58, s47, s56
    s_mov_b32 m0, s58
    s_add_u32 s58, s58, s53
    v_mfma_f32_32x32x16_bf16 v[112:127], a[76:79], v[164:167], v[112:127]
    ds_read_b64_tr_b16 a[24:25], v29 offset:2176
    buffer_load_dwordx4 v1, s[20:23], s58 offen offset:0 sc1 lds
    v_mfma_f32_32x32x16_bf16 v[64:79], a[80:83], v[168:171], v[64:79]
    ds_read_b64_tr_b16 a[26:27], v29 offset:3264
    buffer_load_dwordx4 v1, s[20:23], s58 offen offset:1024 sc1 lds
    v_mfma_f32_32x32x16_bf16 v[80:95], a[84:87], v[168:171], v[80:95]
    ds_read_b64_tr_b16 a[28:29], v29 offset:2240
    s_add_u32 s47, s47, 2048
    s_and_b32 s47, s47, 6144
    s_add_u32 s58, s47, s56
    s_mov_b32 m0, s58
    s_add_u32 s58, s58, s53
    v_mfma_f32_32x32x16_bf16 v[96:111], a[80:83], v[172:175], v[96:111]
    ds_read_b64_tr_b16 a[30:31], v29 offset:3328
    buffer_load_dwordx4 v1, s[20:23], s58 offen offset:0 sc1 lds
    v_mfma_f32_32x32x16_bf16 v[112:127], a[84:87], v[172:175], v[112:127]
    ds_read_b64_tr_b16 a[32:33], v29 offset:4352
    ds_read_b64_tr_b16 a[34:35], v29 offset:5440
    buffer_load_dwordx4 v1, s[20:23], s58 offen offset:1024 sc1 lds
    v_mfma_f32_32x32x16_bf16 v[64:79], a[88:91], v[176:179], v[64:79]
    ds_read_b64_tr_b16 a[36:37], v29 offset:4416
    s_add_u32 s47, s47, 2048
    s_and_b32 s47, s47, 6144
    s_add_u32 s58, s47, s56
    s_mov_b32 m0, s58
    s_add_u32 s58, s58, s53
    v_mfma_f32_32x32x16_bf16 v[80:95], a[92:95], v[176:179], v[80:95]
    ds_read_b64_tr_b16 a[38:39], v29 offset:5504
    buffer_load_dwordx4 v1, s[20:23], s58 offen offset:0 sc1 lds
    s_waitcnt vmcnt(15)
    v_mfma_f32_32x32x16_bf16 v[96:111], a[88:91], v[180:183], v[96:111]
    ds_read_b64_tr_b16 a[40:41], v29 offset:6528
    buffer_load_dwordx4 v1, s[20:23], s58 offen offset:1024 sc1 lds
    v_mfma_f32_32x32x16_bf16 v[112:127], a[92:95], v[180:183], v[112:127]
    s_add_u32 s47, s47, 2048
    s_and_b32 s47, s47, 6144
    s_add_u32 s58, s47, s56
    s_add_u32 s58, s58, 8192
    s_mov_b32 m0, s58
    s_add_u32 s58, s58, s53
    s_waitcnt vmcnt(15)
    v_mfma_f32_32x32x16_bf16 v[64:79], a[96:99], v[184:187], v[64:79]
    ds_read_b64_tr_b16 a[42:43], v29 offset:7616
    ds_read_b64_tr_b16 a[44:45], v29 offset:6592
    buffer_load_dwordx4 v1, s[20:23], s58 offen offset:0 sc1 lds
    v_mfma_f32_32x32x16_bf16 v[80:95], a[100:103], v[184:187], v[80:95]
    ds_read_b64_tr_b16 a[46:47], v29 offset:7680
    buffer_load_dwordx4 v1, s[20:23], s58 offen offset:1024 sc1 lds
    s_waitcnt vmcnt(16)
    v_mfma_f32_32x32x16_bf16 v[96:111], a[96:99], v[188:191], v[96:111]
    s_add_u32 s47, s47, 2048
    s_and_b32 s47, s47, 6144
    s_add_u32 s58, s47, s56
    s_add_u32 s58, s58, 8192
    s_mov_b32 m0, s58
    s_add_u32 s58, s58, s53
    v_mfma_f32_32x32x16_bf16 v[112:127], a[100:103], v[188:191], v[112:127]
    buffer_load_dwordx4 v1, s[20:23], s58 offen offset:0 sc1 lds
    s_waitcnt vmcnt(16)
    v_mfma_f32_32x32x16_bf16 v[64:79], a[104:107], v[192:195], v[64:79]
    buffer_load_dwordx4 v1, s[20:23], s58 offen offset:1024 sc1 lds
    v_mfma_f32_32x32x16_bf16 v[80:95], a[108:111], v[192:195], v[80:95]
    s_mul_i32 s63, s67, 896
    s_add_u32 s63, s63, 10752
    s_waitcnt vmcnt(16)
    v_mfma_f32_32x32x16_bf16 v[96:111], a[104:107], v[196:199], v[96:111]
    buffer_load_dwordx2 v[30:31], v5, s[20:23], s63 offen sc1
    s_add_u32 s47, s47, 2048
    s_and_b32 s47, s47, 6144
    s_add_u32 s58, s47, s56
    s_add_u32 s58, s58, 8192
    v_mfma_f32_32x32x16_bf16 v[112:127], a[108:111], v[196:199], v[112:127]
    s_mov_b32 m0, s58
    s_add_u32 s58, s58, s53
    buffer_load_dwordx4 v1, s[20:23], s58 offen offset:0 sc1 lds
    s_waitcnt vmcnt(17)
    v_mfma_f32_32x32x16_bf16 v[64:79], a[112:115], v[200:203], v[64:79]
    v_mfma_f32_32x32x16_bf16 v[80:95], a[116:119], v[200:203], v[80:95]
    buffer_load_dwordx4 v1, s[20:23], s58 offen offset:1024 sc1 lds
    s_add_u32 s47, s47, 2048
    s_and_b32 s47, s47, 6144
    s_add_u32 s58, s47, s56
    s_add_u32 s58, s58, 8192
    s_waitcnt vmcnt(17)
    v_mfma_f32_32x32x16_bf16 v[96:111], a[112:115], v[204:207], v[96:111]
    s_mov_b32 m0, s58
    s_add_u32 s58, s58, s53
    buffer_load_dwordx4 v1, s[20:23], s58 offen offset:0 sc1 lds
    v_mfma_f32_32x32x16_bf16 v[112:127], a[116:119], v[204:207], v[112:127]
    buffer_load_dwordx4 v1, s[20:23], s58 offen offset:1024 sc1 lds
    s_lshl_b32 s58, s57, 9
    s_add_u32 s58, s58, 65536
    buffer_load_dword v3, v11, s[20:23], s58 offen sc1
    buffer_load_dword v4, v11, s[20:23], s58 offen offset:256 sc1
    s_mul_i32 s15, s67, 14336
    s_add_u32 s15, s15, s32
    s_add_u32 s37, s15, s9
    buffer_load_dwordx4 a[136:139], v1, s[20:23], s37 offen offset:0 sc1
    s_waitcnt vmcnt(21)
    v_mfma_f32_32x32x16_bf16 v[64:79], a[120:123], v[208:211], v[64:79]
    s_waitcnt vmcnt(12)
    ds_read_b128 a[48:51], v12 offset:0
    ds_read_b128 a[52:55], v13 offset:0
    s_add_u32 s37, s15, s10
    buffer_load_dwordx4 a[144:147], v1, s[20:23], s37 offen offset:0 sc1
    v_mfma_f32_32x32x16_bf16 v[80:95], a[124:127], v[208:211], v[80:95]
    ds_read_b128 a[56:59], v14 offset:0
    ds_read_b128 a[60:63], v15 offset:0
    s_add_u32 s37, s15, s11
    v_mfma_f32_32x32x16_bf16 v[96:111], a[120:123], v[212:215], v[96:111]
    ds_read_b128 a[64:67], v16 offset:0
    ds_read_b128 a[68:71], v17 offset:0
    buffer_load_dwordx4 a[152:155], v1, s[20:23], s37 offen offset:0 sc1
    s_add_u32 s37, s15, s12
    v_mfma_f32_32x32x16_bf16 v[112:127], a[124:127], v[212:215], v[112:127]
    ds_read_b128 a[240:243], v18 offset:0
    ds_read_b128 a[244:247], v19 offset:0
    buffer_load_dwordx4 a[160:163], v1, s[20:23], s37 offen offset:0 sc1
    s_waitcnt lgkmcnt(6)
    v_mfma_f32_32x32x16_bf16 v[32:47], a[48:51], v[128:131], 0
    s_add_u32 s37, s15, s13
    v_mfma_f32_32x32x16_bf16 v[32:47], a[52:55], v[132:135], v[32:47]
    buffer_load_dwordx4 a[168:171], v1, s[20:23], s37 offen offset:0 sc1
    s_add_u32 s37, s15, s14
    buffer_load_dwordx4 a[176:179], v1, s[20:23], s37 offen offset:0 sc1
    s_add_u32 s37, s15, s9
    buffer_load_dwordx4 a[140:143], v1, s[20:23], s37 offen offset:1024 sc1
    s_add_u32 s37, s15, s10
    buffer_load_dwordx4 a[148:151], v1, s[20:23], s37 offen offset:1024 sc1
    s_add_u32 s37, s15, s11
    buffer_load_dwordx4 a[156:159], v1, s[20:23], s37 offen offset:1024 sc1
    s_waitcnt lgkmcnt(2)
    v_mfma_f32_32x32x16_bf16 v[32:47], a[56:59], v[136:139], v[32:47]
    s_waitcnt vmcnt(11)
    ds_read_b128 a[248:251], v12 offset:8192
    ds_read_b128 a[252:255], v13 offset:8192
    s_add_u32 s37, s15, s12
    buffer_load_dwordx4 a[164:167], v1, s[20:23], s37 offen offset:1024 sc1
    v_mfma_f32_32x32x16_bf16 v[32:47], a[60:63], v[140:143], v[32:47]
    ds_read_b128 a[184:187], v14 offset:8192
    ds_read_b128 a[188:191], v15 offset:8192
    v_lshrrev_b32 v160, 3, v0
    v_and_b32 v161, 7, v0
    s_lshl_b32 s59, s42, 3
    v_add_u32 v160, s59, v160
    v_mfma_f32_32x32x16_bf16 v[32:47], a[64:67], v[144:147], v[32:47]
    ds_read_b128 a[192:195], v16 offset:8192
    ds_read_b128 a[196:199], v17 offset:8192
    v_mfma_f32_32x32x16_bf16 v[32:47], a[68:71], v[148:151], v[32:47]
    ds_read_b128 a[200:203], v18 offset:8192
    ds_read_b128 a[204:207], v19 offset:8192
    v_lshlrev_b32 v162, 1, v161
    s_waitcnt lgkmcnt(6)
    v_mfma_f32_32x32x16_bf16 v[32:47], a[240:243], v[152:155], v[32:47]
    v_cmp_ne_u64 vcc, s[40:41], v[30:31]
    s_nop 0
    s_and_b32 s68, vcc_lo, 3
    s_cbranch_scc1 L_pr6
L_pd6:
    s_barrier
    v_xor_b32 v162, v162, v160
    v_mfma_f32_32x32x16_bf16 v[32:47], a[244:247], v[156:159], v[32:47]
    s_mul_i32 s51, s67, 14336
    s_add_u32 s51, s51, s33
    s_add_u32 s55, s51, s8
    buffer_load_dwordx4 v[216:219], v1, s[20:23], s55 offen offset:0 sc1
    s_add_u32 s55, s51, s9
    v_mfma_f32_32x32x16_bf16 v[48:63], a[248:251], v[128:131], 0
    buffer_load_dwordx4 v[224:227], v1, s[20:23], s55 offen offset:0 sc1
    v_and_b32 v162, 15, v162
    v_lshlrev_b32 v162, 4, v162
    v_mfma_f32_32x32x16_bf16 v[48:63], a[252:255], v[132:135], v[48:63]
    s_add_u32 s55, s51, s10
    v_lshl_add_u32 v162, v160, 8, v162
    s_waitcnt lgkmcnt(0)
    v_mfma_f32_32x32x16_bf16 v[48:63], a[184:187], v[136:139], v[48:63]
    buffer_load_dwordx4 v[232:235], v1, s[20:23], s55 offen offset:0 sc1
    v_cvt_pk_bf16_f32 v8, v32, v33
    v_cvt_pk_bf16_f32 v9, v34, v35
    v_cvt_pk_bf16_f32 v10, v36, v37
    v_cvt_pk_bf16_f32 v11, v38, v39
    v_mfma_f32_32x32x16_bf16 v[48:63], a[188:191], v[140:143], v[48:63]
    s_add_u32 s55, s51, s11
    v_cvt_pk_bf16_f32 v24, v40, v41
    v_cvt_pk_bf16_f32 v25, v42, v43
    v_cvt_pk_bf16_f32 v26, v44, v45
    v_cvt_pk_bf16_f32 v27, v46, v47
    v_xor_b32 v163, 16, v162
    v_mfma_f32_32x32x16_bf16 v[48:63], a[192:195], v[144:147], v[48:63]
    buffer_load_dwordx4 v[240:243], v1, s[20:23], s55 offen offset:0 sc1
    s_add_u32 s55, s51, s12
    v_lshlrev_b32 v164, 15, v160
    v_mfma_f32_32x32x16_bf16 v[48:63], a[196:199], v[148:151], v[48:63]
    buffer_load_dwordx4 v[248:251], v1, s[20:23], s55 offen offset:0 sc1
    s_add_u32 s55, s51, s13
    v_and_b32 v165, 3, v0
    v_mfma_f32_32x32x16_bf16 v[48:63], a[200:203], v[152:155], v[48:63]
    buffer_load_dwordx4 a[0:3], v1, s[20:23], s55 offen offset:0 sc1
    v_lshl_add_u32 v164, v165, 4, v164
    v_mfma_f32_32x32x16_bf16 v[48:63], a[204:207], v[156:159], v[48:63]
    s_add_u32 s55, s51, s14
    v_bfe_u32 v165, v0, 2, 1
    v_mfma_f32_32x32x16_bf16 v[32:47], v[8:11], a[16:19], 0
    buffer_load_dwordx4 a[8:11], v1, s[20:23], s55 offen offset:0 sc1
    s_add_u32 s37, s15, s13
    v_lshl_add_u32 v164, v165, 9, v164
    v_mfma_f32_32x32x16_bf16 v[144:159], v[8:11], a[20:23], 0
    buffer_load_dwordx4 a[172:175], v1, s[20:23], s37 offen offset:1024 sc1
    s_nop 3
    v_cvt_pk_bf16_f32 v128, v48, v49
    v_cvt_pk_bf16_f32 v129, v50, v51
    v_cvt_pk_bf16_f32 v130, v52, v53
    v_cvt_pk_bf16_f32 v131, v54, v55
    v_mfma_f32_32x32x16_bf16 v[32:47], v[24:27], a[24:27], v[32:47]
    s_add_u32 s37, s15, s14
    v_cvt_pk_bf16_f32 v132, v56, v57
    v_cvt_pk_bf16_f32 v133, v58, v59
    v_cvt_pk_bf16_f32 v134, v60, v61
    v_cvt_pk_bf16_f32 v135, v62, v63
    v_lshlrev_b32 v165, 31, v165
    v_mfma_f32_32x32x16_bf16 v[144:159], v[24:27], a[28:31], v[144:159]
    buffer_load_dwordx4 a[180:183], v1, s[20:23], s37 offen offset:1024 sc1
    s_add_u32 s55, s51, s8
    v_or_b32 v165, 1.0, v165
    v_mfma_f32_32x32x16_bf16 v[32:47], v[128:131], a[32:35], v[32:47]
    buffer_load_dwordx4 v[220:223], v1, s[20:23], s55 offen offset:1024 sc1
    s_lshl_b32 s60, s57, 10
    s_lshl_b32 s50, s49, 31
    s_lshl_b32 s61, s44, 6
    s_waitcnt vmcnt(21)
    v_sub_f32 v20, 1.0, v3
    v_mfma_f32_32x32x16_bf16 v[144:159], v[128:131], a[36:39], v[144:159]
    s_add_u32 s55, s51, s9
    s_add_u32 s60, s60, s61
    s_waitcnt vmcnt(20)
    v_sub_f32 v21, 1.0, v4
    v_mfma_f32_32x32x16_bf16 v[32:47], v[132:135], a[40:43], v[32:47]
    buffer_load_dwordx4 v[228:231], v1, s[20:23], s55 offen offset:1024 sc1
    s_add_u32 s55, s51, s10
    s_add_u32 s61, s60, 1048576
    v_xor_b32 v22, s50, v20
    v_mfma_f32_32x32x16_bf16 v[144:159], v[132:135], a[44:47], v[144:159]
    buffer_load_dwordx4 v[236:239], v1, s[20:23], s55 offen offset:1024 sc1
    v_xor_b32 v23, s50, v21
    s_waitcnt vmcnt(11)
    v_mfma_f32_32x32x16_bf16 v[64:79], a[128:131], v[216:219], v[64:79]
    s_add_u32 s55, s51, s11
    buffer_load_dwordx4 v[244:247], v1, s[20:23], s55 offen offset:1024 sc1
    s_waitcnt vmcnt(11)
    v_mfma_f32_32x32x16_bf16 v[64:79], a[136:139], v[224:227], v[64:79]
    s_add_u32 s55, s51, s12
    buffer_load_dwordx4 v[252:255], v1, s[20:23], s55 offen offset:1024 sc1
    s_add_u32 s55, s51, s13
    s_waitcnt vmcnt(11)
    v_mfma_f32_32x32x16_bf16 v[64:79], a[144:147], v[232:235], v[64:79]
    buffer_load_dwordx4 a[4:7], v1, s[20:23], s55 offen offset:1024 sc1
    v_mul_f32 v32, v3, v32
    v_mul_f32 v33, v3, v33
    v_mul_f32 v34, v3, v34
    v_mul_f32 v35, v3, v35
    s_waitcnt vmcnt(11)
    v_mfma_f32_32x32x16_bf16 v[64:79], a[152:155], v[240:243], v[64:79]
    s_add_u32 s55, s51, s14
    buffer_load_dwordx4 a[12:15], v1, s[20:23], s55 offen offset:1024 sc1
    v_mul_f32 v36, v3, v36
    v_mul_f32 v37, v3, v37
    v_mul_f32 v38, v3, v38
    s_waitcnt vmcnt(11)
    v_mfma_f32_32x32x16_bf16 v[64:79], a[160:163], v[248:251], v[64:79]
    v_mul_f32 v39, v3, v39
    v_mul_f32 v40, v3, v40
    v_mul_f32 v41, v3, v41
    v_mul_f32 v42, v3, v42
    v_mul_f32 v43, v3, v43
    v_mul_f32 v44, v3, v44
    s_waitcnt vmcnt(10)
    v_mfma_f32_32x32x16_bf16 v[64:79], a[168:171], a[0:3], v[64:79]
    v_mul_f32 v45, v3, v45
    v_mul_f32 v46, v3, v46
    v_mul_f32 v47, v3, v47
    v_mul_f32 v144, v4, v144
    v_mul_f32 v145, v4, v145
    v_mul_f32 v146, v4, v146
    s_waitcnt vmcnt(9)
    v_mfma_f32_32x32x16_bf16 v[64:79], a[176:179], a[8:11], v[64:79]
    v_mul_f32 v147, v4, v147
    v_mul_f32 v148, v4, v148
    v_mul_f32 v149, v4, v149
    v_mul_f32 v150, v4, v150
    v_mul_f32 v151, v4, v151
    v_mul_f32 v152, v4, v152
    v_mfma_f32_32x32x16_bf16 v[80:95], a[132:135], v[216:219], v[80:95]
    v_mul_f32 v153, v4, v153
    v_mul_f32 v154, v4, v154
    v_mul_f32 v155, v4, v155
    v_mul_f32 v156, v4, v156
    v_mul_f32 v157, v4, v157
    v_mul_f32 v158, v4, v158
    v_mul_f32 v159, v4, v159
    v_mfma_f32_32x32x16_bf16 v[80:95], a[140:143], v[224:227], v[80:95]
    v_fma_f32 v64, v64, v20, v32
    v_fma_f32 v65, v65, v20, v33
    v_fma_f32 v66, v66, v20, v34
    v_fma_f32 v67, v67, v20, v35
    v_mfma_f32_32x32x16_bf16 v[80:95], a[148:151], v[232:235], v[80:95]
    ds_write_b128 v12, v[64:67] offset:0
    v_fma_f32 v68, v68, v20, v36
    v_mfma_f32_32x32x16_bf16 v[80:95], a[156:159], v[240:243], v[80:95]
    s_add_u32 s53, s2, s42
    s_min_u32 s53, s53, 1
    s_lshl_b32 s53, s53, 30
    v_fma_f32 v69, v69, v20, v37
    v_fma_f32 v70, v70, v20, v38
    v_fma_f32 v71, v71, v20, v39
    v_mfma_f32_32x32x16_bf16 v[80:95], a[164:167], v[248:251], v[80:95]
    ds_write_b128 v13, v[68:71] offset:0
    v_fma_f32 v72, v72, v20, v40
    s_waitcnt vmcnt(8)
    v_mfma_f32_32x32x16_bf16 v[80:95], a[172:175], a[0:3], v[80:95]
    buffer_store_dwordx2 v[6:7], v2, s[20:23], s53 offen sc1
    v_fma_f32 v73, v73, v20, v41
    v_fma_f32 v74, v74, v20, v42
    v_fma_f32 v75, v75, v20, v43
    s_waitcnt vmcnt(8)
    v_mfma_f32_32x32x16_bf16 v[80:95], a[180:183], a[8:11], v[80:95]
    ds_write_b128 v14, v[72:75] offset:0
    v_fma_f32 v76, v76, v20, v44
    s_waitcnt vmcnt(7)
    v_mfma_f32_32x32x16_bf16 v[96:111], a[128:131], v[220:223], v[96:111]
    v_fma_f32 v77, v77, v20, v45
    v_fma_f32 v78, v78, v20, v46
    v_fma_f32 v79, v79, v20, v47
    s_waitcnt vmcnt(6)
    v_mfma_f32_32x32x16_bf16 v[96:111], a[136:139], v[228:231], v[96:111]
    ds_write_b128 v15, v[76:79] offset:0
    s_nop 1
    v_fma_f32 v80, v80, v22, v32
    s_waitcnt vmcnt(5)
    v_mfma_f32_32x32x16_bf16 v[96:111], a[144:147], v[236:239], v[96:111]
    v_fma_f32 v81, v81, v22, v33
    v_fma_f32 v82, v82, v22, v34
    v_fma_f32 v83, v83, v22, v35
    s_waitcnt vmcnt(4)
    v_mfma_f32_32x32x16_bf16 v[96:111], a[152:155], v[244:247], v[96:111]
    ds_write_b128 v16, v[80:83] offset:0
    v_fma_f32 v84, v84, v22, v36
    s_waitcnt vmcnt(3)
    v_mfma_f32_32x32x16_bf16 v[96:111], a[160:163], v[252:255], v[96:111]
    v_fma_f32 v85, v85, v22, v37
    v_fma_f32 v86, v86, v22, v38
    v_fma_f32 v87, v87, v22, v39
    s_waitcnt vmcnt(2)
    v_mfma_f32_32x32x16_bf16 v[96:111], a[168:171], a[4:7], v[96:111]
    ds_write_b128 v17, v[84:87] offset:0
    v_fma_f32 v88, v88, v22, v40
    s_waitcnt vmcnt(1)
    v_mfma_f32_32x32x16_bf16 v[96:111], a[176:179], a[12:15], v[96:111]
    v_fma_f32 v89, v89, v22, v41
    v_fma_f32 v90, v90, v22, v42
    v_fma_f32 v91, v91, v22, v43
    v_mfma_f32_32x32x16_bf16 v[112:127], a[132:135], v[220:223], v[112:127]
    ds_write_b128 v18, v[88:91] offset:0
    v_fma_f32 v92, v92, v22, v44
    v_mfma_f32_32x32x16_bf16 v[112:127], a[140:143], v[228:231], v[112:127]
    v_fma_f32 v93, v93, v22, v45
    v_fma_f32 v94, v94, v22, v46
    v_fma_f32 v95, v95, v22, v47
    ds_write_b128 v19, v[92:95] offset:0
    v_mfma_f32_32x32x16_bf16 v[112:127], a[148:151], v[236:239], v[112:127]
    v_fma_f32 v96, v96, v21, v144
    v_fma_f32 v97, v97, v21, v145
    v_fma_f32 v98, v98, v21, v146
    v_fma_f32 v99, v99, v21, v147
    v_mfma_f32_32x32x16_bf16 v[112:127], a[156:159], v[244:247], v[112:127]
    ds_write_b128 v12, v[96:99] offset:8192
    v_fma_f32 v100, v100, v21, v148
    v_mfma_f32_32x32x16_bf16 v[112:127], a[164:167], v[252:255], v[112:127]
    s_waitcnt lgkmcnt(1)
    s_barrier
    v_mfma_f32_32x32x16_bf16 v[112:127], a[172:175], a[4:7], v[112:127]
    s_branch L_ld_m5
.p2align 12
L_st_m5:
L_wB_m5:
    s_branch L_retB
L_wQ_m5:
    s_branch L_retQ
L_ld_m5:
    v_fma_f32 v101, v101, v21, v149
    v_fma_f32 v102, v102, v21, v150
    v_fma_f32 v103, v103, v21, v151
    v_mfma_f32_32x32x16_bf16 v[112:127], a[180:183], a[12:15], v[112:127]
    ds_write_b128 v13, v[100:103] offset:8192
    v_fma_f32 v104, v104, v21, v152
    v_fma_f32 v105, v105, v21, v153
    v_fma_f32 v106, v106, v21, v154
    v_fma_f32 v107, v107, v21, v155
    ds_write_b128 v14, v[104:107] offset:8192
    v_fma_f32 v108, v108, v21, v156
    v_fma_f32 v109, v109, v21, v157
    v_fma_f32 v110, v110, v21, v158
    v_fma_f32 v111, v111, v21, v159
    ds_write_b128 v15, v[108:111] offset:8192
    ds_read_b128 v[64:67], v162 offset:0
    ds_read_b128 v[68:71], v163 offset:0
    ds_read_b128 v[72:75], v162 offset:16384
    ds_read_b128 v[76:79], v163 offset:16384
    ds_read_b128 v[80:83], v162 offset:32768
    ds_read_b128 v[84:87], v163 offset:32768
    ds_read_b128 v[88:91], v162 offset:49152
    ds_read_b128 v[92:95], v163 offset:49152
    v_fma_f32 v112, v112, v23, v144
    v_fma_f32 v113, v113, v23, v145
    v_fma_f32 v114, v114, v23, v146
    v_fma_f32 v115, v115, v23, v147
    ds_write_b128 v16, v[112:115] offset:8192
    v_fma_f32 v116, v116, v23, v148
    v_fma_f32 v117, v117, v23, v149
    v_fma_f32 v118, v118, v23, v150
    v_fma_f32 v119, v119, v23, v151
    ds_write_b128 v17, v[116:119] offset:8192
    v_fma_f32 v120, v120, v23, v152
    v_fma_f32 v121, v121, v23, v153
    v_fma_f32 v122, v122, v23, v154
    v_fma_f32 v123, v123, v23, v155
    ds_write_b128 v18, v[120:123] offset:8192
    v_fma_f32 v124, v124, v23, v156
    v_fma_f32 v125, v125, v23, v157
    v_fma_f32 v126, v126, v23, v158
    v_fma_f32 v127, v127, v23, v159
    ds_write_b128 v19, v[124:127] offset:8192
    s_waitcnt lgkmcnt(7)
    v_pk_add_f32 v[64:65], v[64:65], v[80:81]
    s_waitcnt lgkmcnt(5)
    v_pk_add_f32 v[72:73], v[72:73], v[88:89]
    v_pk_add_f32 v[66:67], v[66:67], v[82:83]
    v_pk_add_f32 v[74:75], v[74:75], v[90:91]
    v_pk_add_f32 v[68:69], v[68:69], v[84:85]
    s_waitcnt lgkmcnt(4)
    v_pk_add_f32 v[76:77], v[76:77], v[92:93]
    v_pk_add_f32 v[70:71], v[70:71], v[86:87]
    v_pk_add_f32 v[78:79], v[78:79], v[94:95]
    v_fmac_f32 v64, v165, v72
    v_fmac_f32 v65, v165, v73
    v_fmac_f32 v66, v165, v74
    v_fmac_f32 v67, v165, v75
    v_fmac_f32 v68, v165, v76
    v_fmac_f32 v69, v165, v77
    v_fmac_f32 v70, v165, v78
    v_fmac_f32 v71, v165, v79
    v_cvt_pk_bf16_f32 v72, v64, v65
    v_cvt_pk_bf16_f32 v73, v66, v67
    v_cvt_pk_bf16_f32 v74, v68, v69
    v_cvt_pk_bf16_f32 v75, v70, v71
    buffer_store_dwordx4 v[72:75], v164, s[24:27], s60 offen sc1 nt
    s_waitcnt lgkmcnt(0)
    s_barrier
    ds_read_b128 v[32:35], v162 offset:8192
    ds_read_b128 v[36:39], v163 offset:8192
    ds_read_b128 v[40:43], v162 offset:24576
    ds_read_b128 v[44:47], v163 offset:24576
    ds_read_b128 v[48:51], v162 offset:40960
    ds_read_b128 v[52:55], v163 offset:40960
    ds_read_b128 v[56:59], v162 offset:57344
    ds_read_b128 v[60:63], v163 offset:57344
    s_waitcnt lgkmcnt(3)
    v_pk_add_f32 v[32:33], v[32:33], v[48:49]
    s_waitcnt lgkmcnt(1)
    v_pk_add_f32 v[40:41], v[40:41], v[56:57]
    v_pk_add_f32 v[34:35], v[34:35], v[50:51]
    v_pk_add_f32 v[42:43], v[42:43], v[58:59]
    v_pk_add_f32 v[36:37], v[36:37], v[52:53]
    s_waitcnt lgkmcnt(0)
    v_pk_add_f32 v[44:45], v[44:45], v[60:61]
    v_pk_add_f32 v[38:39], v[38:39], v[54:55]
    v_pk_add_f32 v[46:47], v[46:47], v[62:63]
    v_fmac_f32 v32, v165, v40
    v_fmac_f32 v33, v165, v41
    v_fmac_f32 v34, v165, v42
    v_fmac_f32 v35, v165, v43
    v_fmac_f32 v36, v165, v44
    v_fmac_f32 v37, v165, v45
    v_fmac_f32 v38, v165, v46
    v_fmac_f32 v39, v165, v47
    v_cvt_pk_bf16_f32 v40, v32, v33
    v_cvt_pk_bf16_f32 v41, v34, v35
    v_cvt_pk_bf16_f32 v42, v36, v37
    v_cvt_pk_bf16_f32 v43, v38, v39
    buffer_store_dwordx4 v[40:43], v164, s[24:27], s61 offen sc1 nt
L_end:
    s_endpgm
.p2align 12
L_p2:
    s_cmp_eq_u32 s43, 0
    s_cselect_b32 s69, -992, s43
    s_cmp_eq_u32 s48, 0
    s_cselect_b32 s8, s32, s36
    s_cselect_b32 s9, s33, s37
    s_mov_b32 s10, 1052672
    s_mov_b32 s11, 0x20000
    s_sub_i32 s18, 1984, s43
    s_sub_i32 s17, 960, s69
    s_add_i32 s59, s69, 1024
    s_cmp_eq_u32 s49, 0
    s_cselect_b32 s18, s43, s18
    s_cselect_b32 s17, s59, s17
    s_cselect_b32 s16, 1, -1
    s_mul_i32 s18, s18, 514
    s_mul_i32 s17, s17, 514
    s_add_u32 s18, s18, 2
    s_and_b32 s18, s18, -4
    s_add_u32 s17, s17, 2
    s_and_b32 s17, s17, -4
    s_mul_i32 s16, s16, 65792
    v_lshrrev_b32 v153, 5, v0
    v_or_b32 v20, s43, v153
    v_min_u32 v20, 1, v20
    v_xor_b32 v20, 1, v20
    v_xor_b32 v153, s49, v153
    v_mul_u32_u24 v153, 32896, v153
    v_and_b32 v152, 31, v0
    v_lshl_add_u32 v152, v152, 4, v153
    s_mul_i32 s59, s49, 526336
    v_mul_lo_u32 v153, v20, s59
    v_add_u32 v154, s18, v152
    v_sub_u32 v154, v154, v153
    s_add_u32 m0, s56, 65536
    s_nop 0
    buffer_load_dwordx4 v154, s[8:11], 0 offen lds
    v_and_b32 v128, 3, v0
    v_bfe_u32 v129, v0, 3, 2
    v_lshl_add_u32 v128, v129, 2, v128
    v_bfe_u32 v129, v0, 2, 1
    v_lshl_add_u32 v128, v129, 4, v128
    s_lshr_b32 s61, s44, 1
    s_lshl_b32 s61, s61, 6
    s_and_b32 s60, s44, 1
    s_add_u32 s60, s60, s61
    v_lshl_add_u32 v128, v128, 1, s60
    s_add_u32 m0, s56, 66560
    s_add_u32 s18, s18, s16
    buffer_load_dwordx4 v152, s[8:11], s18 offen lds
    v_cvt_f32_u32 v129, s48
    v_mul_f32 v129, 0xbe800000, v129
    s_lshl_b32 s61, s48, 8
    v_mov_b32 v130, s61
    v_cmp_eq_u32 vcc, 0, v128
    v_lshrrev_b32 v131, 5, v0
    s_lshl_b32 s61, s57, 7
    v_cndmask_b32 v128, v128, v130, vcc
    v_cndmask_b32 v129, v129, 0, vcc
    v_cvt_f32_u32 v128, v128
    s_add_u32 m0, s56, 67584
    s_add_u32 s18, s18, s16
    buffer_load_dwordx4 v152, s[8:11], s18 offen lds
    v_mul_f32 v128, 0x3b000000, v128
    v_lshl_add_u32 v131, v131, 3, s61
    v_cvt_f32_u32 v131, v131
    v_fmac_f32 v129, v131, v128
    v_mul_f32 v130, 0x41800000, v128
    v_mov_b32 v132, v129
    v_add_f32 v140, v130, v129
    v_cos_f32 v130, v130
    v_add_f32 v133, v128, v132
    v_add_f32 v141, v128, v140
    s_add_u32 m0, s52, 16384
    s_add_u32 s58, s50, s29
    buffer_load_dwordx4 v8, s[4:7], s58 offen lds
    v_add_f32 v134, v128, v133
    v_add_f32 v142, v128, v141
    v_add_f32 v135, v128, v134
    v_add_f32 v143, v128, v142
    v_add_f32 v136, v128, v135
    v_add_f32 v144, v128, v143
    v_add_f32 v137, v128, v136
    v_add_f32 v145, v128, v144
    v_add_f32 v138, v128, v137
    v_add_f32 v146, v128, v145
    buffer_load_dwordx4 v9, s[4:7], s58 offen offset:1024 lds
    v_add_f32 v139, v128, v138
    v_add_f32 v147, v128, v146
    v_add_f32 v130, v130, v130
    v_mov_b32 v131, v130
    v_cos_f32 v132, v132
    v_cos_f32 v133, v133
    v_cos_f32 v134, v134
    v_cos_f32 v135, v135
    v_cos_f32 v136, v136
    v_cos_f32 v137, v137
    buffer_load_dwordx4 v10, s[4:7], s58 offen offset:2048 lds
    v_cos_f32 v138, v138
    v_cos_f32 v139, v139
    v_cos_f32 v140, v140
    v_cos_f32 v141, v141
    v_cos_f32 v142, v142
    v_cos_f32 v143, v143
    v_cos_f32 v144, v144
    v_cos_f32 v145, v145
    v_cos_f32 v146, v146
    v_cos_f32 v147, v147
    buffer_load_dwordx4 v11, s[4:7], s58 offen offset:3072 lds
    v_cvt_pk_bf16_f32 v64, v132, v133
    v_cvt_pk_bf16_f32 v65, v134, v135
    v_cvt_pk_bf16_f32 v66, v136, v137
    v_cvt_pk_bf16_f32 v67, v138, v139
    v_cvt_pk_bf16_f32 v68, v140, v141
    v_cvt_pk_bf16_f32 v69, v142, v143
    v_cvt_pk_bf16_f32 v70, v144, v145
    v_cvt_pk_bf16_f32 v71, v146, v147
    v_pk_fma_f32 v[132:133], v[130:131], v[140:141], v[132:133] neg_lo:[0,0,1] neg_hi:[0,0,1]
    v_pk_fma_f32 v[134:135], v[130:131], v[142:143], v[134:135] neg_lo:[0,0,1] neg_hi:[0,0,1]
    s_cmp_eq_u32 s42, 0
    s_cbranch_scc1 L_wP_p1
    s_cmp_eq_u32 s42, 1
    s_cbranch_scc1 L_wP_p2
    s_cmp_eq_u32 s42, 2
    s_cbranch_scc1 L_wP_p3
L_retP:
    v_pk_fma_f32 v[136:137], v[130:131], v[144:145], v[136:137] neg_lo:[0,0,1] neg_hi:[0,0,1]
    v_pk_fma_f32 v[138:139], v[130:131], v[146:147], v[138:139] neg_lo:[0,0,1] neg_hi:[0,0,1]
    v_cvt_pk_bf16_f32 v72, v132, v133
    v_cvt_pk_bf16_f32 v73, v134, v135
    v_cvt_pk_bf16_f32 v74, v136, v137
    v_cvt_pk_bf16_f32 v75, v138, v139
    v_pk_fma_f32 v[140:141], v[130:131], v[132:133], v[140:141] neg_lo:[0,0,1] neg_hi:[0,0,1]
    v_pk_fma_f32 v[142:143], v[130:131], v[134:135], v[142:143] neg_lo:[0,0,1] neg_hi:[0,0,1]
    v_pk_fma_f32 v[144:145], v[130:131], v[136:137], v[144:145] neg_lo:[0,0,1] neg_hi:[0,0,1]
    v_pk_fma_f32 v[146:147], v[130:131], v[138:139], v[146:147] neg_lo:[0,0,1] neg_hi:[0,0,1]
    s_add_u32 m0, s52, 32768
    s_add_u32 s58, s50, s30
    buffer_load_dwordx4 v8, s[4:7], s58 offen lds
    v_cvt_pk_bf16_f32 v76, v140, v141
    v_cvt_pk_bf16_f32 v77, v142, v143
    v_cvt_pk_bf16_f32 v78, v144, v145
    v_cvt_pk_bf16_f32 v79, v146, v147
    v_pk_fma_f32 v[132:133], v[130:131], v[140:141], v[132:133] neg_lo:[0,0,1] neg_hi:[0,0,1]
    v_pk_fma_f32 v[134:135], v[130:131], v[142:143], v[134:135] neg_lo:[0,0,1] neg_hi:[0,0,1]
    v_pk_fma_f32 v[136:137], v[130:131], v[144:145], v[136:137] neg_lo:[0,0,1] neg_hi:[0,0,1]
    v_pk_fma_f32 v[138:139], v[130:131], v[146:147], v[138:139] neg_lo:[0,0,1] neg_hi:[0,0,1]
    v_cvt_pk_bf16_f32 v80, v132, v133
    v_cvt_pk_bf16_f32 v81, v134, v135
    buffer_load_dwordx4 v9, s[4:7], s58 offen offset:1024 lds
    v_cvt_pk_bf16_f32 v82, v136, v137
    v_cvt_pk_bf16_f32 v83, v138, v139
    v_pk_fma_f32 v[140:141], v[130:131], v[132:133], v[140:141] neg_lo:[0,0,1] neg_hi:[0,0,1]
    v_pk_fma_f32 v[142:143], v[130:131], v[134:135], v[142:143] neg_lo:[0,0,1] neg_hi:[0,0,1]
    v_pk_fma_f32 v[144:145], v[130:131], v[136:137], v[144:145] neg_lo:[0,0,1] neg_hi:[0,0,1]
    v_pk_fma_f32 v[146:147], v[130:131], v[138:139], v[146:147] neg_lo:[0,0,1] neg_hi:[0,0,1]
    v_cvt_pk_bf16_f32 v84, v140, v141
    v_cvt_pk_bf16_f32 v85, v142, v143
    v_cvt_pk_bf16_f32 v86, v144, v145
    v_cvt_pk_bf16_f32 v87, v146, v147
    buffer_load_dwordx4 v10, s[4:7], s58 offen offset:2048 lds
    v_pk_fma_f32 v[132:133], v[130:131], v[140:141], v[132:133] neg_lo:[0,0,1] neg_hi:[0,0,1]
    v_pk_fma_f32 v[134:135], v[130:131], v[142:143], v[134:135] neg_lo:[0,0,1] neg_hi:[0,0,1]
    v_pk_fma_f32 v[136:137], v[130:131], v[144:145], v[136:137] neg_lo:[0,0,1] neg_hi:[0,0,1]
    v_pk_fma_f32 v[138:139], v[130:131], v[146:147], v[138:139] neg_lo:[0,0,1] neg_hi:[0,0,1]
    v_cvt_pk_bf16_f32 v88, v132, v133
    v_cvt_pk_bf16_f32 v89, v134, v135
    v_cvt_pk_bf16_f32 v90, v136, v137
    v_cvt_pk_bf16_f32 v91, v138, v139
    v_pk_fma_f32 v[140:141], v[130:131], v[132:133], v[140:141] neg_lo:[0,0,1] neg_hi:[0,0,1]
    v_pk_fma_f32 v[142:143], v[130:131], v[134:135], v[142:143] neg_lo:[0,0,1] neg_hi:[0,0,1]
    buffer_load_dwordx4 v11, s[4:7], s58 offen offset:3072 lds
    v_pk_fma_f32 v[144:145], v[130:131], v[136:137], v[144:145] neg_lo:[0,0,1] neg_hi:[0,0,1]
    v_pk_fma_f32 v[146:147], v[130:131], v[138:139], v[146:147] neg_lo:[0,0,1] neg_hi:[0,0,1]
    v_cvt_pk_bf16_f32 v92, v140, v141
    v_cvt_pk_bf16_f32 v93, v142, v143
    v_cvt_pk_bf16_f32 v94, v144, v145
    v_cvt_pk_bf16_f32 v95, v146, v147
    v_pk_fma_f32 v[132:133], v[130:131], v[140:141], v[132:133] neg_lo:[0,0,1] neg_hi:[0,0,1]
    v_pk_fma_f32 v[134:135], v[130:131], v[142:143], v[134:135] neg_lo:[0,0,1] neg_hi:[0,0,1]
    v_pk_fma_f32 v[136:137], v[130:131], v[144:145], v[136:137] neg_lo:[0,0,1] neg_hi:[0,0,1]
    v_pk_fma_f32 v[138:139], v[130:131], v[146:147], v[138:139] neg_lo:[0,0,1] neg_hi:[0,0,1]
    buffer_load_dwordx2 v[6:7], off, s[20:23], 0 sc1
    v_cvt_pk_bf16_f32 v96, v132, v133
    v_cvt_pk_bf16_f32 v97, v134, v135
    v_cvt_pk_bf16_f32 v98, v136, v137
    v_cvt_pk_bf16_f32 v99, v138, v139
    v_pk_fma_f32 v[140:141], v[130:131], v[132:133], v[140:141] neg_lo:[0,0,1] neg_hi:[0,0,1]
    v_pk_fma_f32 v[142:143], v[130:131], v[134:135], v[142:143] neg_lo:[0,0,1] neg_hi:[0,0,1]
    v_pk_fma_f32 v[144:145], v[130:131], v[136:137], v[144:145] neg_lo:[0,0,1] neg_hi:[0,0,1]
    v_pk_fma_f32 v[146:147], v[130:131], v[138:139], v[146:147] neg_lo:[0,0,1] neg_hi:[0,0,1]
    v_cvt_pk_bf16_f32 v100, v140, v141
    v_cvt_pk_bf16_f32 v101, v142, v143
    s_mov_b32 s12, s14
    s_mov_b32 s13, s15
    s_mov_b32 s14, 1024
    s_mov_b32 s15, 0x20000
    v_add_u32 v156, s28, v1
    v_and_b32 v156, 1023, v156
    s_mov_b32 m0, 157184
    s_nop 0
    buffer_load_dwordx4 v156, s[12:15], 0 offen lds
    v_cvt_pk_bf16_f32 v102, v144, v145
    v_cvt_pk_bf16_f32 v103, v146, v147
    v_pk_fma_f32 v[132:133], v[130:131], v[140:141], v[132:133] neg_lo:[0,0,1] neg_hi:[0,0,1]
    v_pk_fma_f32 v[134:135], v[130:131], v[142:143], v[134:135] neg_lo:[0,0,1] neg_hi:[0,0,1]
    v_pk_fma_f32 v[136:137], v[130:131], v[144:145], v[136:137] neg_lo:[0,0,1] neg_hi:[0,0,1]
    v_pk_fma_f32 v[138:139], v[130:131], v[146:147], v[138:139] neg_lo:[0,0,1] neg_hi:[0,0,1]
    v_cvt_pk_bf16_f32 v104, v132, v133
    v_cvt_pk_bf16_f32 v105, v134, v135
    v_cvt_pk_bf16_f32 v106, v136, v137
    v_cvt_pk_bf16_f32 v107, v138, v139
    s_add_u32 m0, s52, 49152
    s_add_u32 s58, s50, s31
    buffer_load_dwordx4 v8, s[4:7], s58 offen lds
    v_pk_fma_f32 v[140:141], v[130:131], v[132:133], v[140:141] neg_lo:[0,0,1] neg_hi:[0,0,1]
    v_pk_fma_f32 v[142:143], v[130:131], v[134:135], v[142:143] neg_lo:[0,0,1] neg_hi:[0,0,1]
    v_pk_fma_f32 v[144:145], v[130:131], v[136:137], v[144:145] neg_lo:[0,0,1] neg_hi:[0,0,1]
    v_pk_fma_f32 v[146:147], v[130:131], v[138:139], v[146:147] neg_lo:[0,0,1] neg_hi:[0,0,1]
    v_cvt_pk_bf16_f32 v108, v140, v141
    v_cvt_pk_bf16_f32 v109, v142, v143
    v_cvt_pk_bf16_f32 v110, v144, v145
    v_cvt_pk_bf16_f32 v111, v146, v147
    v_pk_fma_f32 v[132:133], v[130:131], v[140:141], v[132:133] neg_lo:[0,0,1] neg_hi:[0,0,1]
    v_pk_fma_f32 v[134:135], v[130:131], v[142:143], v[134:135] neg_lo:[0,0,1] neg_hi:[0,0,1]
    buffer_load_dwordx4 v9, s[4:7], s58 offen offset:1024 lds
    v_pk_fma_f32 v[136:137], v[130:131], v[144:145], v[136:137] neg_lo:[0,0,1] neg_hi:[0,0,1]
    v_pk_fma_f32 v[138:139], v[130:131], v[146:147], v[138:139] neg_lo:[0,0,1] neg_hi:[0,0,1]
    v_cvt_pk_bf16_f32 v112, v132, v133
    v_cvt_pk_bf16_f32 v113, v134, v135
    v_cvt_pk_bf16_f32 v114, v136, v137
    v_cvt_pk_bf16_f32 v115, v138, v139
    v_pk_fma_f32 v[140:141], v[130:131], v[132:133], v[140:141] neg_lo:[0,0,1] neg_hi:[0,0,1]
    v_pk_fma_f32 v[142:143], v[130:131], v[134:135], v[142:143] neg_lo:[0,0,1] neg_hi:[0,0,1]
    v_pk_fma_f32 v[144:145], v[130:131], v[136:137], v[144:145] neg_lo:[0,0,1] neg_hi:[0,0,1]
    v_pk_fma_f32 v[146:147], v[130:131], v[138:139], v[146:147] neg_lo:[0,0,1] neg_hi:[0,0,1]
    buffer_load_dwordx4 v10, s[4:7], s58 offen offset:2048 lds
    v_cvt_pk_bf16_f32 v116, v140, v141
    v_cvt_pk_bf16_f32 v117, v142, v143
    v_cvt_pk_bf16_f32 v118, v144, v145
    v_cvt_pk_bf16_f32 v119, v146, v147
    v_pk_fma_f32 v[132:133], v[130:131], v[140:141], v[132:133] neg_lo:[0,0,1] neg_hi:[0,0,1]
    v_pk_fma_f32 v[134:135], v[130:131], v[142:143], v[134:135] neg_lo:[0,0,1] neg_hi:[0,0,1]
    v_pk_fma_f32 v[136:137], v[130:131], v[144:145], v[136:137] neg_lo:[0,0,1] neg_hi:[0,0,1]
    v_pk_fma_f32 v[138:139], v[130:131], v[146:147], v[138:139] neg_lo:[0,0,1] neg_hi:[0,0,1]
    v_cvt_pk_bf16_f32 v120, v132, v133
    v_cvt_pk_bf16_f32 v121, v134, v135
    buffer_load_dwordx4 v11, s[4:7], s58 offen offset:3072 lds
    v_cvt_pk_bf16_f32 v122, v136, v137
    v_cvt_pk_bf16_f32 v123, v138, v139
    v_pk_fma_f32 v[140:141], v[130:131], v[132:133], v[140:141] neg_lo:[0,0,1] neg_hi:[0,0,1]
    v_pk_fma_f32 v[142:143], v[130:131], v[134:135], v[142:143] neg_lo:[0,0,1] neg_hi:[0,0,1]
    v_pk_fma_f32 v[144:145], v[130:131], v[136:137], v[144:145] neg_lo:[0,0,1] neg_hi:[0,0,1]
    v_pk_fma_f32 v[146:147], v[130:131], v[138:139], v[146:147] neg_lo:[0,0,1] neg_hi:[0,0,1]
    v_cvt_pk_bf16_f32 v124, v140, v141
    v_cvt_pk_bf16_f32 v125, v142, v143
    v_cvt_pk_bf16_f32 v126, v144, v145
    v_cvt_pk_bf16_f32 v127, v146, v147
    s_add_u32 m0, s56, 68608
    s_add_u32 s18, s18, s16
    buffer_load_dwordx4 v152, s[8:11], s18 offen lds
    v_and_b32 v128, 15, v0
    v_and_b32 v130, 31, v0
    s_lshl_b32 s60, s49, 13
    v_lshl_add_u32 v130, v130, 8, s60
    v_lshrrev_b32 v131, 5, v0
    v_xor_b32 v131, v131, v128
    v_lshl_add_u32 v12, v131, 4, v130
    v_xor_b32 v13, 32, v12
    v_xor_b32 v14, 64, v12
    v_xor_b32 v15, 96, v12
    s_add_u32 m0, s56, 69632
    s_add_u32 s18, s18, s16
    buffer_load_dwordx4 v152, s[8:11], s18 offen lds
    v_xor_b32 v16, 128, v12
    v_xor_b32 v17, 160, v12
    v_xor_b32 v18, 192, v12
    v_xor_b32 v19, 224, v12
    v_and_b32 v128, 15, v0
    s_lshl_b32 s59, s42, 4
    v_add_u32 v128, s59, v128
    v_and_b32 v131, 1, v0
    v_lshrrev_b32 v129, 1, v128
    v_cvt_f32_u32 v131, v131
    s_add_u32 m0, s56, 70656
    s_add_u32 s18, s18, s16
    buffer_load_dwordx4 v152, s[8:11], s18 offen lds
    v_cvt_f32_u32 v129, v129
    v_cmp_eq_u32 vcc, 1, v128
    v_mul_f32 v131, 0xbe800000, v131
    v_mul_f32 v129, 0x3c800000, v129
    v_and_b32 v130, 48, v0
    v_cndmask_b32 v131, v131, 0, vcc
    v_cndmask_b32 v129, v129, 0.5, vcc
    v_cvt_f32_u32 v132, v130
    v_mul_u32_u24 v128, 136, v128
    v_fmac_f32 v131, v132, v129
    s_add_u32 m0, s56, 71680
    s_add_u32 s18, s18, s16
    buffer_load_dwordx4 v152, s[8:11], s18 offen lds
    v_lshl_add_u32 v130, v130, 1, v128
    v_add_u32 v130, 147456, v130
    v_fmamk_f32 v132, v129, 0x00000000, v131
    v_fmamk_f32 v133, v129, 0x3f800000, v131
    v_fmamk_f32 v134, v129, 0x40000000, v131
    v_fmamk_f32 v135, v129, 0x40400000, v131
    v_fmamk_f32 v136, v129, 0x40800000, v131
    v_fmamk_f32 v137, v129, 0x40a00000, v131
    v_fmamk_f32 v138, v129, 0x40c00000, v131
    v_fmamk_f32 v139, v129, 0x40e00000, v131
    v_cos_f32 v132, v132
    v_cos_f32 v133, v133
    v_cos_f32 v134, v134
    v_cos_f32 v135, v135
    v_cos_f32 v136, v136
    v_cos_f32 v137, v137
    v_cos_f32 v138, v138
    v_cos_f32 v139, v139
    v_cvt_pk_bf16_f32 v132, v132, v133
    v_cvt_pk_bf16_f32 v133, v134, v135
    v_cvt_pk_bf16_f32 v134, v136, v137
    v_cvt_pk_bf16_f32 v135, v138, v139
    ds_write2_b64 v130, v[132:133], v[134:135] offset0:0 offset1:1
    v_fmamk_f32 v132, v129, 0x41000000, v131
    v_fmamk_f32 v133, v129, 0x41100000, v131
    v_fmamk_f32 v134, v129, 0x41200000, v131
    v_fmamk_f32 v135, v129, 0x41300000, v131
    v_fmamk_f32 v136, v129, 0x41400000, v131
    v_fmamk_f32 v137, v129, 0x41500000, v131
    v_fmamk_f32 v138, v129, 0x41600000, v131
    v_fmamk_f32 v139, v129, 0x41700000, v131
    v_cos_f32 v132, v132
    v_cos_f32 v133, v133
    v_cos_f32 v134, v134
    v_cos_f32 v135, v135
    v_cos_f32 v136, v136
    v_cos_f32 v137, v137
    v_cos_f32 v138, v138
    v_cos_f32 v139, v139
    v_cvt_pk_bf16_f32 v132, v132, v133
    v_cvt_pk_bf16_f32 v133, v134, v135
    v_cvt_pk_bf16_f32 v134, v136, v137
    v_cvt_pk_bf16_f32 v135, v138, v139
    ds_write2_b64 v130, v[132:133], v[134:135] offset0:2 offset1:3
    s_waitcnt vmcnt(14) lgkmcnt(0)
    s_barrier
    ds_read_b128 a[0:3], v12 offset:0
    ds_read_b128 a[4:7], v13 offset:0
    ds_read_b128 a[8:11], v14 offset:0
    ds_read_b128 a[12:15], v15 offset:0
    ds_read_b128 a[16:19], v16 offset:0
    ds_read_b128 a[20:23], v17 offset:0
    s_waitcnt lgkmcnt(5)
    v_mfma_f32_32x32x16_bf16 v[32:47], a[0:3], v[64:67], 0
    ds_read_b128 a[24:27], v18 offset:0
    ds_read_b128 a[28:31], v19 offset:0
    s_add_u32 m0, s56, 72704
    s_add_u32 s18, s18, s16
    v_lshrrev_b32 v22, 4, v0
    v_and_b32 v180, 15, v0
    s_waitcnt lgkmcnt(6)
    v_mfma_f32_32x32x16_bf16 v[32:47], a[4:7], v[68:71], v[32:47]
    ds_read_b128 a[32:35], v12 offset:16384
    ds_read_b128 a[36:39], v13 offset:16384
    buffer_load_dwordx4 v152, s[8:11], s18 offen lds
    v_xor_b32 v23, v22, v180
    s_waitcnt lgkmcnt(7)
    v_mfma_f32_32x32x16_bf16 v[32:47], a[8:11], v[72:75], v[32:47]
    ds_read_b128 a[40:43], v14 offset:16384
    s_add_u32 m0, s56, 73728
    s_mov_b32 s18, s17
    v_lshlrev_b32 v23, 4, v23
    v_lshl_add_u32 v23, v180, 8, v23
    v_add_u32 v180, s52, v23
    s_waitcnt lgkmcnt(5)
    v_mfma_f32_32x32x16_bf16 v[32:47], a[12:15], v[76:79], v[32:47]
    ds_read_b128 a[44:47], v15 offset:16384
    ds_read_b128 a[48:51], v16 offset:16384
    buffer_load_dwordx4 v152, s[8:11], s18 offen lds
    v_lshlrev_b32 v22, 4, v22
    v_mfma_f32_32x32x16_bf16 v[32:47], a[16:19], v[80:83], v[32:47]
    ds_read_b128 a[52:55], v17 offset:16384
    v_add_u32 v22, 157184, v22
    v_xor_b32 v181, 64, v180
    v_xor_b32 v182, 128, v180
    v_xor_b32 v183, 192, v180
    v_lshrrev_b32 v2, 4, v0
    v_mfma_f32_32x32x16_bf16 v[32:47], a[20:23], v[84:87], v[32:47]
    ds_read_b128 a[56:59], v18 offset:16384
    ds_read_b128 a[60:63], v19 offset:16384
    s_add_u32 m0, s56, 74752
    s_add_u32 s18, s18, s16
    v_lshlrev_b32 v2, 28, v2
    v_lshl_add_u32 v2, v0, 3, v2
    s_waitcnt lgkmcnt(5)
    v_mfma_f32_32x32x16_bf16 v[32:47], a[24:27], v[88:91], v[32:47]
    buffer_load_dwordx4 v152, s[8:11], s18 offen lds
    v_and_b32 v31, 31, v0
    v_mul_u32_u24 v28, 136, v31
    v_mfma_f32_32x32x16_bf16 v[32:47], a[28:31], v[92:95], v[32:47]
    s_waitcnt vmcnt(7)
    s_barrier
    v_mfma_f32_32x32x16_bf16 v[32:47], a[32:35], v[96:99], v[32:47]
    ds_read_b128 a[64:67], v12 offset:32768
    ds_read_b128 a[68:71], v13 offset:32768
    s_add_u32 m0, s56, 75776
    s_add_u32 s18, s18, s16
    v_mfma_f32_32x32x16_bf16 v[32:47], a[36:39], v[100:103], v[32:47]
    ds_read_b128 a[72:75], v14 offset:32768
    ds_read_b128 a[76:79], v15 offset:32768
    buffer_load_dwordx4 v152, s[8:11], s18 offen lds
    v_mfma_f32_32x32x16_bf16 v[32:47], a[40:43], v[104:107], v[32:47]
    ds_read_b128 a[80:83], v16 offset:32768
    ds_read_b128 a[84:87], v17 offset:32768
    s_waitcnt lgkmcnt(6)
    v_mfma_f32_32x32x16_bf16 v[32:47], a[44:47], v[108:111], v[32:47]
    ds_read_b128 a[88:91], v18 offset:32768
    ds_read_b128 a[92:95], v19 offset:32768
    v_mfma_f32_32x32x16_bf16 v[32:47], a[48:51], v[112:115], v[32:47]
    ds_read_b128 a[96:99], v12 offset:49152
    ds_read_b128 a[100:103], v13 offset:49152
    s_cmp_eq_u32 s43, 0
    s_cselect_b32 s47, 1.0, 0
    v_and_b32 v128, 31, v0
    v_lshrrev_b32 v129, 4, v128
    v_mfma_f32_32x32x16_bf16 v[32:47], a[52:55], v[116:119], v[32:47]
    ds_read_b128 a[104:107], v14 offset:49152
    ds_read_b128 a[108:111], v15 offset:49152
    s_sub_i32 s53, s69, s43
    v_mul_i32_i24 v130, s53, v129
    v_lshl_add_u32 v130, v128, 6, v130
    v_add_u32 v130, s43, v130
    v_mfma_f32_32x32x16_bf16 v[32:47], a[56:59], v[120:123], v[32:47]
    ds_read_b128 a[112:115], v16 offset:49152
    s_xor_b32 s59, s42, 1
    s_lshl_b32 s59, s59, 11
    s_add_u32 s59, s59, 139264
    v_lshl_add_u32 v30, v31, 6, s59
    v_add_u32 v4, s59, v1
    v_mfma_f32_32x32x16_bf16 v[32:47], a[60:63], v[124:127], v[32:47]
    ds_read_b128 a[116:119], v17 offset:49152
    ds_read_b128 a[120:123], v18 offset:49152
    v_xor_b32 v3, 2048, v4
    v_lshrrev_b32 v31, 5, v0
    v_lshl_add_u32 v28, v31, 3, v28
    v_lshl_add_u32 v30, v31, 5, v30
    s_waitcnt lgkmcnt(5)
    v_mfma_f32_32x32x16_bf16 v[48:63], a[64:67], v[64:67], 0
    ds_read_b128 a[124:127], v19 offset:49152
    ds_read_b128 a[128:131], v180 offset:0
    s_mul_i32 s59, s49, 4288
    s_add_u32 s59, s59, 147520
    v_add_u32 v29, s59, v28
    v_cmp_eq_u32 vcc, 0, v130
    v_mfma_f32_32x32x16_bf16 v[48:63], a[68:71], v[68:71], v[48:63]
    ds_read_b128 a[132:135], v181 offset:0
    ds_read_b128 a[136:139], v182 offset:0
    s_mul_i32 s59, s49, 4416
    s_add_u32 s59, s59, 147456
    v_add_u32 v28, s59, v28
    v_bfe_u32 v31, v0, 1, 2
    v_mfma_f32_32x32x16_bf16 v[48:63], a[72:75], v[72:75], v[48:63]
    ds_read_b128 a[140:143], v183 offset:0
    ds_read_b128 a[144:147], v180 offset:16384
    v_lshlrev_b32 v31, 4, v31
    v_xor_b32 v30, v31, v30
    v_xor_b32 v31, 16, v30
    v_cvt_f32_u32 v130, v130
    v_mfma_f32_32x32x16_bf16 v[48:63], a[76:79], v[76:79], v[48:63]
    ds_read_b128 a[148:151], v181 offset:16384
    v_readfirstlane_b32 s40, v6
    v_readfirstlane_b32 s41, v7
    v_mul_f32 v130, 0x3a000000, v130
    v_cvt_f32_u32 v129, v129
    v_mfma_f32_32x32x16_bf16 v[48:63], a[80:83], v[80:83], v[48:63]
    ds_read_b128 a[152:155], v182 offset:16384
    ds_read_b128 a[156:159], v183 offset:16384
    s_mul_i32 s40, s40, 0x9E3779B1
    s_add_u32 s40, s40, 0x7F4A7C15
    s_mul_i32 s41, s41, 0x85EBCA6D
    s_add_u32 s41, s41, 0xC2B2AE35
    v_mfma_f32_32x32x16_bf16 v[48:63], a[84:87], v[84:87], v[48:63]
    ds_read_b128 a[160:163], v180 offset:32768
    v_mov_b32 v6, s40
    v_mov_b32 v7, s41
    v_mul_f32 v149, s47, v129
    v_sub_f32 v148, 1.0, v149
    v_sub_f32 v150, 1.0, s47
    v_mfma_f32_32x32x16_bf16 v[48:63], a[88:91], v[88:91], v[48:63]
    ds_read_b128 a[164:167], v181 offset:32768
    ds_read_b128 a[168:171], v182 offset:32768
    s_and_b32 s61, s44, 1
    s_lshl_b32 s61, s61, 31
    s_or_b32 s61, s61, 0x3f800000
    s_lshl_b32 s60, s43, 3
    v_mfma_f32_32x32x16_bf16 v[48:63], a[92:95], v[92:95], v[48:63]
    ds_read_b128 a[172:175], v183 offset:32768
    s_add_u32 s60, s60, s44
    s_lshl_b32 s60, s60, 2
    s_add_u32 s60, s60, s42
    s_lshl_b32 s60, s60, 11
    s_add_u32 s60, s60, 1048576
    v_mfma_f32_32x32x16_bf16 v[48:63], a[96:99], v[96:99], v[48:63]
    ds_read_b128 a[176:179], v180 offset:49152
    ds_read_b128 a[180:183], v181 offset:49152
    v_cndmask_b32 v151, 0, 1.0, vcc
    v_lshrrev_b32 v131, 5, v0
    v_mfma_f32_32x32x16_bf16 v[48:63], a[100:103], v[100:103], v[48:63]
    ds_read_b128 a[184:187], v182 offset:49152
    s_lshl_b32 s53, s42, 3
    v_lshl_add_u32 v129, v131, 1, s53
    v_cvt_f32_u32 v129, v129
    v_mul_f32 v129, v129, v130
    v_fmamk_f32 v136, v130, 0x00000000, v129
    s_waitcnt lgkmcnt(4)
    v_mfma_f32_32x32x16_bf16 v[48:63], a[104:107], v[104:107], v[48:63]
    ds_read_b128 a[188:191], v183 offset:49152
    v_fmamk_f32 v137, v130, 0x3f800000, v129
    v_fmamk_f32 v138, v130, 0x40800000, v129
    v_fmamk_f32 v139, v130, 0x40a00000, v129
    v_cos_f32 v132, v136
    v_mfma_f32_32x32x16_bf16 v[48:63], a[108:111], v[108:111], v[48:63]
    ds_read2_b64 a[232:235], v28 offset0:0 offset1:2
    v_sin_f32 v136, v136
    v_cos_f32 v133, v137
    v_mfma_f32_32x32x16_bf16 v[48:63], a[112:115], v[112:115], v[48:63]
    ds_read2_b64 a[236:239], v28 offset0:4 offset1:6
    v_sin_f32 v137, v137
    v_cos_f32 v134, v138
    v_mfma_f32_32x32x16_bf16 v[48:63], a[116:119], v[116:119], v[48:63]
    ds_read2_b64 a[240:243], v29 offset0:0 offset1:2
    v_sin_f32 v138, v138
    v_cos_f32 v135, v139
    v_mfma_f32_32x32x16_bf16 v[48:63], a[120:123], v[120:123], v[48:63]
    ds_read2_b64 a[244:247], v29 offset0:4 offset1:6
    v_sin_f32 v139, v139
    v_add_f32 v136, v136, v151
    v_sub_f32 v137, v137, v151
    v_add_f32 v138, v138, v151
    v_mfma_f32_32x32x16_bf16 v[48:63], a[124:127], v[124:127], v[48:63]
    v_sub_f32 v139, v139, v151
    v_mul_f32 v160, v148, v132
    v_mul_f32 v161, v149, v132
    v_mul_f32 v162, v148, v136
    v_mul_f32 v163, v150, v132
    v_fma_f32 v161, -v136, v150, v161
    v_lshrrev_b32 v120, 5, v0
    v_and_b32 v121, 31, v0
    v_lshlrev_b32 v121, 2, v121
    v_lshl_add_u32 v120, v120, 11, v121
    s_lshl_b32 s59, s42, 7
    s_add_u32 s59, s59, 65536
    s_and_b32 s58, s43, 1
    s_lshl_b32 s58, s58, 1
    s_sub_u32 s59, s59, s58
    v_add_u32 v122, s59, v120
    v_cvt_f32_u32 v121, v20
    v_sub_f32 v20, 1.0, v121
    v_pk_fma_f32 v[32:33], v[48:49], s[60:61], v[32:33] op_sel:[0,1,0] op_sel_hi:[1,1,1]
    v_pk_fma_f32 v[34:35], v[50:51], s[60:61], v[34:35] op_sel:[0,1,0] op_sel_hi:[1,1,1]
    v_pk_fma_f32 v[36:37], v[52:53], s[60:61], v[36:37] op_sel:[0,1,0] op_sel_hi:[1,1,1]
    v_pk_fma_f32 v[38:39], v[54:55], s[60:61], v[38:39] op_sel:[0,1,0] op_sel_hi:[1,1,1]
    v_cvt_pk_bf16_f32 v96, v32, v33
    v_cvt_pk_bf16_f32 v97, v34, v35
    v_cvt_pk_bf16_f32 v98, v36, v37
    v_cvt_pk_bf16_f32 v99, v38, v39
    ds_write_b128 v3, v[96:99] offset:0
    v_pk_fma_f32 v[40:41], v[56:57], s[60:61], v[40:41] op_sel:[0,1,0] op_sel_hi:[1,1,1]
    v_pk_fma_f32 v[42:43], v[58:59], s[60:61], v[42:43] op_sel:[0,1,0] op_sel_hi:[1,1,1]
    v_pk_fma_f32 v[44:45], v[60:61], s[60:61], v[44:45] op_sel:[0,1,0] op_sel_hi:[1,1,1]
    v_pk_fma_f32 v[46:47], v[62:63], s[60:61], v[46:47] op_sel:[0,1,0] op_sel_hi:[1,1,1]
    v_cvt_pk_bf16_f32 v100, v40, v41
    v_cvt_pk_bf16_f32 v101, v42, v43
    v_cvt_pk_bf16_f32 v102, v44, v45
    v_cvt_pk_bf16_f32 v103, v46, v47
    ds_write_b128 v3, v[100:103] offset:1024
    s_waitcnt lgkmcnt(4)
    v_mfma_f32_32x32x16_bf16 v[32:47], v[96:99], a[232:235], 0
    s_branch L_ld_p1
.p2align 12
L_st_p1:
L_wP_p1:
    s_branch L_retP
L_ld_p1:
    v_mfma_f32_32x32x16_bf16 v[32:47], v[100:103], a[236:239], v[32:47]
    s_waitcnt lgkmcnt(0)
    s_barrier
    ds_read_b128 v[104:107], v4 offset:0
    ds_read_b128 v[108:111], v4 offset:1024
    v_mov_b64 v[192:193], 0
    v_mov_b64 v[194:195], 0
    v_mov_b64 v[196:197], 0
    v_mov_b64 v[198:199], 0
    v_mov_b64 v[200:201], 0
    v_mov_b64 v[202:203], 0
    v_mov_b64 v[204:205], 0
    v_mov_b64 v[206:207], 0
    v_mov_b64 v[208:209], 0
    v_mov_b64 v[210:211], 0
    v_mov_b64 v[212:213], 0
    v_mov_b64 v[214:215], 0
    v_mov_b64 v[216:217], 0
    v_mov_b64 v[218:219], 0
    v_mov_b64 v[220:221], 0
    v_mov_b64 v[222:223], 0
    s_waitcnt lgkmcnt(1)
    v_mfma_f32_32x32x16_bf16 v[32:47], v[104:107], a[240:243], v[32:47]
    s_waitcnt lgkmcnt(0)
    v_mfma_f32_32x32x16_bf16 v[32:47], v[108:111], a[244:247], v[32:47]
    s_nop 11
    v_cvt_pk_bf16_f32 v48, v32, v33
    v_cvt_pk_bf16_f32 v49, v34, v35
    v_cvt_pk_bf16_f32 v50, v36, v37
    v_cvt_pk_bf16_f32 v51, v38, v39
    ds_write_b128 v30, v[48:51]
    v_cvt_pk_bf16_f32 v52, v40, v41
    v_cvt_pk_bf16_f32 v53, v42, v43
    v_cvt_pk_bf16_f32 v54, v44, v45
    v_cvt_pk_bf16_f32 v55, v46, v47
    ds_write_b128 v31, v[52:55]
    ds_read_b128 v[56:59], v4 offset:0
    ds_read_b128 v[60:63], v4 offset:1024
    v_mov_b64 v[224:225], 0
    v_mov_b64 v[226:227], 0
    v_mov_b64 v[228:229], 0
    v_mov_b64 v[230:231], 0
    v_mov_b64 v[232:233], 0
    v_mov_b64 v[234:235], 0
    v_mov_b64 v[236:237], 0
    v_mov_b64 v[238:239], 0
    v_mov_b64 v[240:241], 0
    v_mov_b64 v[242:243], 0
    v_mov_b64 v[244:245], 0
    v_mov_b64 v[246:247], 0
    v_mov_b64 v[248:249], 0
    v_mov_b64 v[250:251], 0
    v_mov_b64 v[252:253], 0
    v_mov_b64 v[254:255], 0
    s_waitcnt lgkmcnt(0)
    buffer_store_dwordx4 v[56:59], v1, s[20:23], s60 offen sc1
    buffer_store_dwordx4 v[60:63], v1, s[20:23], s60 offen offset:1024 sc1
    s_lshl_b32 s54, s43, 7
    s_add_u32 s54, s54, 16384
    s_cmp_eq_u32 s42, 0
    s_cselect_b32 s54, s54, 0x40000000
    buffer_store_dwordx2 v[0:1], v2, s[20:23], s54 offen sc1
    s_add_u32 m0, s56, 76800
    s_add_u32 s18, s18, s16
    buffer_load_dwordx4 v152, s[8:11], s18 offen lds
    s_add_u32 m0, s56, 77824
    s_add_u32 s18, s18, s16
    buffer_load_dwordx4 v152, s[8:11], s18 offen lds
    s_add_u32 m0, s56, 78848
    s_add_u32 s18, s18, s16
    buffer_load_dwordx4 v152, s[8:11], s18 offen lds
    s_add_u32 m0, s56, 79872
    s_add_u32 s18, s18, s16
    buffer_load_dwordx4 v152, s[8:11], s18 offen lds
    s_add_u32 m0, s56, 80896
    s_add_u32 s18, s18, s16
    buffer_load_dwordx4 v152, s[8:11], s18 offen lds
    v_and_b32 v184, 31, v0
    v_lshrrev_b32 v185, 4, v184
    s_sub_i32 s19, s69, s43
    v_mul_i32_i24 v185, s19, v185
    v_lshl_add_u32 v184, v184, 6, v185
    v_add_u32 v186, s43, v184
    v_sub_u32 v185, 2048, v186
    v_lshrrev_b32 v21, 11, v185
    v_lshrrev_b32 v185, v21, v185
    v_sub_u32 v185, v185, v186
    v_lshrrev_b32 v184, 5, v0
    v_mul_i32_i24 v185, v185, v184
    v_add_u32 v185, v185, v186
    v_mul_u32_u24 v185, 514, v185
    s_lshl_b32 s19, s49, 9
    buffer_load_ushort v187, v185, s[8:11], s19 offen
    s_lshl_b32 s59, s42, 13
    s_add_u32 s59, s59, 32768
    v_lshl_add_u32 v9, v0, 7, s59
    s_lshl_b32 s60, s44, 5
    s_add_u32 s60, s60, s43
    s_lshl_b32 s60, s60, 7
    s_add_u32 s60, s60, 32768
    s_cmp_eq_u32 s42, 0
    s_cselect_b32 s60, s60, 0x40000000
    v_fmac_f32 v163, v149, v136
    v_cvt_pk_bf16_f32 v164, v160, v161
    v_cvt_pk_bf16_f32 v168, v162, v163
    v_mul_f32 v160, v148, v133
    v_mul_f32 v161, v149, v133
    v_mul_f32 v162, v148, v137
    v_mul_f32 v163, v150, v133
    v_fma_f32 v161, -v137, v150, v161
    v_fmac_f32 v163, v149, v137
    v_cvt_pk_bf16_f32 v165, v160, v161
    v_cvt_pk_bf16_f32 v169, v162, v163
    v_mul_f32 v160, v148, v134
    v_mul_f32 v161, v149, v134
    v_mul_f32 v162, v148, v138
    v_mul_f32 v163, v150, v134
    v_fma_f32 v161, -v138, v150, v161
    v_fmac_f32 v163, v149, v138
    v_cvt_pk_bf16_f32 v166, v160, v161
    v_cvt_pk_bf16_f32 v170, v162, v163
    v_mul_f32 v160, v148, v135
    v_mul_f32 v161, v149, v135
    v_mul_f32 v162, v148, v139
    v_mul_f32 v163, v150, v135
    v_fma_f32 v161, -v139, v150, v161
    v_fmac_f32 v163, v149, v139
    v_cvt_pk_bf16_f32 v167, v160, v161
    v_cvt_pk_bf16_f32 v171, v162, v163
    s_cmp_ge_u32 s42, 2
    s_cselect_b32 s53, s69, s43
    s_cselect_b32 s55, s47, 0
    v_mov_b32 v149, s55
    s_lshl_b32 s55, s42, 9
    s_add_i32 s53, s53, s55
    v_lshl_add_u32 v129, v131, 8, s53
    v_cmp_eq_u32 vcc, 0, v129
    v_cvt_f32_u32 v129, v129
    v_cvt_f32_u32 v130, v128
    v_mul_f32 v130, 0x3a000000, v130
    v_mul_f32 v129, v129, v130
    v_and_b32 v151, 1, v0
    v_cvt_f32_u32 v151, v151
    v_fma_f32 v151, v151, -2.0, 1.0
    v_cndmask_b32 v151, 0, v151, vcc
    v_sub_f32 v148, 1.0, v149
    v_mul_f32 v148, 0x36000000, v148
    v_mul_f32 v149, 0x36000000, v149
    v_mul_f32 v150, 0x36000000, v150
    v_fmamk_f32 v136, v130, 0x00000000, v129
    v_fmamk_f32 v137, v130, 0x42800000, v129
    v_fmamk_f32 v138, v130, 0x43000000, v129
    v_fmamk_f32 v139, v130, 0x43400000, v129
    v_cos_f32 v132, v136
    v_sin_f32 v136, v136
    v_cos_f32 v133, v137
    v_sin_f32 v137, v137
    v_cos_f32 v134, v138
    v_sin_f32 v138, v138
    v_cos_f32 v135, v139
    v_sin_f32 v139, v139
    v_add_f32 v136, v136, v151
    v_mul_f32 v160, v148, v132
    v_mul_f32 v161, v149, v132
    v_mul_f32 v162, v148, v136
    v_mul_f32 v163, v150, v132
    v_fma_f32 v161, -v136, v150, v161
    v_fmac_f32 v163, v149, v136
    v_cvt_pk_bf16_f32 v172, v160, v162
    v_cvt_pk_bf16_f32 v176, v161, v163
    v_mul_f32 v160, v148, v133
    v_mul_f32 v161, v149, v133
    v_mul_f32 v162, v148, v137
    v_mul_f32 v163, v150, v133
    v_fma_f32 v161, -v137, v150, v161
    v_fmac_f32 v163, v149, v137
    v_cvt_pk_bf16_f32 v173, v160, v162
    v_cvt_pk_bf16_f32 v177, v161, v163
    v_mul_f32 v160, v148, v134
    v_mul_f32 v161, v149, v134
    v_mul_f32 v162, v148, v138
    v_mul_f32 v163, v150, v134
    v_fma_f32 v161, -v138, v150, v161
    v_fmac_f32 v163, v149, v138
    v_cvt_pk_bf16_f32 v174, v160, v162
    v_cvt_pk_bf16_f32 v178, v161, v163
    v_mul_f32 v160, v148, v135
    v_mul_f32 v161, v149, v135
    v_mul_f32 v162, v148, v139
    v_mul_f32 v163, v150, v135
    v_fma_f32 v161, -v139, v150, v161
    v_fmac_f32 v163, v149, v139
    v_cvt_pk_bf16_f32 v175, v160, v162
    v_cvt_pk_bf16_f32 v179, v161, v163
    s_lshr_b32 s38, s52, 1
    s_add_u32 s59, s38, 131072
    v_add_u32 v158, s59, v1
    v_add_u32 v10, 131072, v1
    ds_write_b128 v158, v[164:167]
    ds_write_b128 v158, v[168:171] offset:1024
    ds_write_b128 v4, v[172:175]
    ds_write_b128 v4, v[176:179] offset:1024
    ds_read_b128 v[128:131], v22 offset:0
    ds_read_b128 v[132:135], v22 offset:64
    ds_read_b128 v[136:139], v22 offset:128
    ds_read_b128 v[140:143], v22 offset:192
    ds_read_b128 v[144:147], v22 offset:256
    ds_read_b128 v[148:151], v22 offset:320
    ds_read_b128 v[152:155], v22 offset:384
    ds_read_b128 v[156:159], v22 offset:448
    s_add_u32 s64, s45, 0
    s_and_b32 s64, s64, 3
    s_add_u32 s57, s46, s64
    s_sub_u32 s65, s64, 1
    s_and_b32 s65, s65, 3
    s_sub_u32 s66, s64, 2
    s_and_b32 s66, s66, 3
    s_sub_u32 s67, s64, 3
    s_and_b32 s67, s67, 3
    s_lshl_b32 s32, s44, 2
    s_add_u32 s32, s32, s42
    s_mul_i32 s32, s32, 57344
    s_waitcnt lgkmcnt(7)
    v_mfma_f32_16x16x32_bf16 v[108:111], v[128:131], a[128:131], 0
    s_waitcnt lgkmcnt(6)
    v_mfma_f32_16x16x32_bf16 v[108:111], v[132:135], a[132:135], v[108:111]
    s_waitcnt lgkmcnt(5)
    v_mfma_f32_16x16x32_bf16 v[108:111], v[136:139], a[136:139], v[108:111]
    s_waitcnt lgkmcnt(0)
    v_mfma_f32_16x16x32_bf16 v[108:111], v[140:143], a[140:143], v[108:111]
    v_mfma_f32_16x16x32_bf16 v[108:111], v[144:147], a[144:147], v[108:111]
    v_mfma_f32_16x16x32_bf16 v[108:111], v[148:151], a[148:151], v[108:111]
    v_mfma_f32_16x16x32_bf16 v[108:111], v[152:155], a[152:155], v[108:111]
    v_mfma_f32_16x16x32_bf16 v[108:111], v[156:159], a[156:159], v[108:111]
    s_cmp_eq_u32 s42, 0
    s_cbranch_scc1 L_wQ_m4
    s_cmp_eq_u32 s42, 1
    s_cbranch_scc1 L_wQ_m5
L_retQ:
    s_waitcnt vmcnt(7)
    s_barrier
    buffer_store_dwordx2 v[6:7], v2, s[20:23], s60 offen sc1
    ds_read_b128 v[128:131], v22 offset:512
    ds_read_b128 v[132:135], v22 offset:576
    ds_read_b128 v[136:139], v22 offset:640
    ds_read_b128 v[140:143], v22 offset:704
    ds_read_b128 v[144:147], v22 offset:768
    ds_read_b128 v[148:151], v22 offset:832
    ds_read_b128 v[152:155], v22 offset:896
    ds_read_b128 v[156:159], v22 offset:960
    s_add_u32 s32, s32, 12582912
    s_lshl_b32 s33, s57, 2
    s_add_u32 s33, s33, s42
    s_mul_i32 s33, s33, 57344
    s_add_u32 s33, s33, 5242880
    s_and_b32 s69, s57, 28
    s_mul_i32 s69, s69, 3584
    s_add_u32 s69, s69, 524288
    s_waitcnt lgkmcnt(7)
    v_mfma_f32_16x16x32_bf16 v[108:111], v[128:131], a[160:163], v[108:111]
    s_waitcnt lgkmcnt(6)
    v_mfma_f32_16x16x32_bf16 v[108:111], v[132:135], a[164:167], v[108:111]
    s_waitcnt lgkmcnt(5)
    v_mfma_f32_16x16x32_bf16 v[108:111], v[136:139], a[168:171], v[108:111]
    s_waitcnt lgkmcnt(0)
    v_mfma_f32_16x16x32_bf16 v[108:111], v[140:143], a[172:175], v[108:111]
    v_mfma_f32_16x16x32_bf16 v[108:111], v[144:147], a[176:179], v[108:111]
    v_mfma_f32_16x16x32_bf16 v[108:111], v[148:151], a[180:183], v[108:111]
    v_mfma_f32_16x16x32_bf16 v[108:111], v[152:155], a[184:187], v[108:111]
    v_mfma_f32_16x16x32_bf16 v[108:111], v[156:159], a[188:191], v[108:111]
    s_lshl_b32 s59, s42, 1
    v_add_u32 v96, s59, v0
    v_min_u32 v96, 6, v96
    v_lshl_add_u32 v5, v96, 7, s69
    v_lshrrev_b32 v96, 1, v0
    v_min_u32 v96, 1, v96
    v_lshl_add_u32 v5, v96, 30, v5
    v_and_b32 v96, 7, v0
    s_lshr_b32 s59, s44, 1
    s_lshl_b32 s59, s59, 2
    s_add_u32 s59, s59, s42
    s_lshl_b32 s63, s59, 7
    s_add_u32 s59, s63, 98304
    v_lshl_add_u32 v28, v96, 12, s59
    v_bfe_u32 v96, v0, 3, 1
    v_lshl_add_u32 v28, v96, 11, v28
    v_lshrrev_b32 v96, 4, v0
    v_lshl_add_u32 v28, v96, 28, v28
    v_and_b32 v112, 31, v0
    v_lshlrev_b32 v112, 2, v112
    s_lshl_b32 s59, s43, 2
    s_add_u32 s59, s59, s42
    s_lshl_b32 s59, s59, 7
    s_add_u32 s61, s59, 65536
    v_mul_f32 v108, 0xbfb8aa3b, v108
    v_exp_f32 v108, v108
    s_nop 0
    v_add_f32 v108, 1.0, v108
    v_rcp_f32 v108, v108
    s_nop 0
    buffer_store_dword v108, v112, s[20:23], s61 offen sc1
    ds_read_b128 a[136:139], v10 offset:0
    ds_read_b128 a[140:143], v10 offset:1024
    ds_read_b128 a[144:147], v10 offset:10240
    ds_read_b128 a[148:151], v10 offset:11264
    ds_read_b128 a[152:155], v10 offset:2048
    ds_read_b128 a[156:159], v10 offset:3072
    ds_read_b128 a[160:163], v10 offset:8192
    ds_read_b128 a[164:167], v10 offset:9216
    ds_read_b128 a[168:171], v10 offset:4096
    ds_read_b128 a[172:175], v10 offset:5120
    ds_read_b128 a[176:179], v10 offset:14336
    ds_read_b128 a[180:183], v10 offset:15360
    ds_read_b128 a[240:243], v10 offset:6144
    ds_read_b128 a[244:247], v10 offset:7168
    ds_read_b128 a[248:251], v10 offset:12288
    ds_read_b128 a[252:255], v10 offset:13312
    s_mov_b32 s8, 0
    s_mov_b32 s9, 2048
    s_mov_b32 s10, 4096
    s_mov_b32 s11, 6144
    s_mov_b32 s12, 8192
    s_mov_b32 s13, 10240
    s_mov_b32 s14, 12288
    v_accvgpr_write_b32 a184, 0
    v_accvgpr_write_b32 a185, 0
    v_accvgpr_write_b32 a186, 0
    v_accvgpr_write_b32 a187, 0
    v_accvgpr_write_b32 a188, 0
    v_accvgpr_write_b32 a189, 0
    v_accvgpr_write_b32 a190, 0
    v_accvgpr_write_b32 a191, 0
    v_accvgpr_write_b32 a192, 0
    v_accvgpr_write_b32 a193, 0
    v_accvgpr_write_b32 a194, 0
    v_accvgpr_write_b32 a195, 0
    v_accvgpr_write_b32 a196, 0
    v_accvgpr_write_b32 a197, 0
    v_accvgpr_write_b32 a198, 0
    v_accvgpr_write_b32 a199, 0
    v_accvgpr_write_b32 a200, 0
    v_accvgpr_write_b32 a201, 0
    v_accvgpr_write_b32 a202, 0
    v_accvgpr_write_b32 a203, 0
    v_accvgpr_write_b32 a204, 0
    v_accvgpr_write_b32 a205, 0
    v_accvgpr_write_b32 a206, 0
    v_accvgpr_write_b32 a207, 0
    v_accvgpr_write_b32 a208, 0
    v_accvgpr_write_b32 a209, 0
    v_accvgpr_write_b32 a210, 0
    v_accvgpr_write_b32 a211, 0
    v_accvgpr_write_b32 a212, 0
    v_accvgpr_write_b32 a213, 0
    v_accvgpr_write_b32 a214, 0
    v_accvgpr_write_b32 a215, 0
    v_xor_b32 v96, s43, v0
    v_bfe_u32 v97, v0, 3, 1
    v_and_b32 v96, 3, v96
    v_lshrrev_b32 v99, 4, v0
    v_lshlrev_b32 v96, 4, v96
    v_lshrrev_b32 v98, 2, v0
    v_lshl_add_u32 v96, v97, 6, v96
    v_xor_b32 v98, v98, v99
    v_and_b32 v98, 1, v98
    v_lshl_add_u32 v96, v98, 12, v96
    v_lshl_add_u32 v29, v99, 16, v96
    s_lshl_b32 s47, s43, 7
    s_add_u32 s47, s47, s56
    s_add_u32 s47, s47, 1048576
    s_lshl_b32 s59, s42, 8
    s_add_u32 s59, s59, 156160
    v_lshl_add_u32 v100, v0, 2, s59
    s_waitcnt vmcnt(2)
    v_lshlrev_b32 v8, 16, v187
    v_mul_f32 v8, 0.5, v8
    ds_write_b32 v100, v8
    s_waitcnt lgkmcnt(0)
    s_barrier
    ds_read_u16_d16_hi v192, v122 offset:0
    ds_read_u16_d16_hi v193, v122 offset:512
    ds_read_u16_d16_hi v208, v122 offset:16384
    ds_read_u16_d16_hi v209, v122 offset:16896
    ds_read_u16_d16_hi v224, v122 offset:32768
    ds_read_u16_d16_hi v225, v122 offset:33280
    ds_read_u16_d16_hi v240, v122 offset:49152
    ds_read_u16_d16_hi v241, v122 offset:49664
    v_accvgpr_write_b32 a216, 0
    v_accvgpr_write_b32 a217, 0
    v_accvgpr_write_b32 a218, 0
    v_accvgpr_write_b32 a219, 0
    ds_read_u16_d16_hi v194, v122 offset:1024
    ds_read_u16_d16_hi v195, v122 offset:1536
    ds_read_u16_d16_hi v210, v122 offset:17408
    ds_read_u16_d16_hi v211, v122 offset:17920
    ds_read_u16_d16_hi v226, v122 offset:33792
    ds_read_u16_d16_hi v227, v122 offset:34304
    ds_read_u16_d16_hi v242, v122 offset:50176
    ds_read_u16_d16_hi v243, v122 offset:50688
    v_accvgpr_write_b32 a220, 0
    v_accvgpr_write_b32 a221, 0
    v_accvgpr_write_b32 a222, 0
    v_accvgpr_write_b32 a223, 0
    ds_read_u16_d16_hi v196, v122 offset:4096
    ds_read_u16_d16_hi v197, v122 offset:4608
    ds_read_u16_d16_hi v212, v122 offset:20480
    ds_read_u16_d16_hi v213, v122 offset:20992
    ds_read_u16_d16_hi v228, v122 offset:36864
    ds_read_u16_d16_hi v229, v122 offset:37376
    ds_read_u16_d16_hi v244, v122 offset:53248
    ds_read_u16_d16_hi v245, v122 offset:53760
    v_accvgpr_write_b32 a224, 0
    v_accvgpr_write_b32 a225, 0
    v_accvgpr_write_b32 a226, 0
    v_accvgpr_write_b32 a227, 0
    ds_read_u16_d16_hi v198, v122 offset:5120
    ds_read_u16_d16_hi v199, v122 offset:5632
    ds_read_u16_d16_hi v214, v122 offset:21504
    ds_read_u16_d16_hi v215, v122 offset:22016
    ds_read_u16_d16_hi v230, v122 offset:37888
    ds_read_u16_d16_hi v231, v122 offset:38400
    ds_read_u16_d16_hi v246, v122 offset:54272
    ds_read_u16_d16_hi v247, v122 offset:54784
    v_accvgpr_write_b32 a228, 0
    v_accvgpr_write_b32 a229, 0
    v_accvgpr_write_b32 a230, 0
    v_accvgpr_write_b32 a231, 0
    ds_read_u16_d16_hi v200, v122 offset:8192
    ds_read_u16_d16_hi v201, v122 offset:8704
    ds_read_u16_d16_hi v216, v122 offset:24576
    ds_read_u16_d16_hi v217, v122 offset:25088
    ds_read_u16_d16_hi v232, v122 offset:40960
    ds_read_u16_d16_hi v233, v122 offset:41472
    ds_read_u16_d16_hi v248, v122 offset:57344
    ds_read_u16_d16_hi v249, v122 offset:57856
    v_accvgpr_write_b32 a232, 0
    v_accvgpr_write_b32 a233, 0
    v_accvgpr_write_b32 a234, 0
    v_accvgpr_write_b32 a235, 0
    ds_read_u16_d16_hi v202, v122 offset:9216
    ds_read_u16_d16_hi v203, v122 offset:9728
    ds_read_u16_d16_hi v218, v122 offset:25600
    ds_read_u16_d16_hi v219, v122 offset:26112
    ds_read_u16_d16_hi v234, v122 offset:41984
    ds_read_u16_d16_hi v235, v122 offset:42496
    ds_read_u16_d16_hi v250, v122 offset:58368
    ds_read_u16_d16_hi v251, v122 offset:58880
    v_accvgpr_write_b32 a236, 0
    v_accvgpr_write_b32 a237, 0
    v_accvgpr_write_b32 a238, 0
    v_accvgpr_write_b32 a239, 0
    ds_read_u16_d16_hi v204, v122 offset:12288
    ds_read_u16_d16_hi v205, v122 offset:12800
    ds_read_u16_d16_hi v220, v122 offset:28672
    ds_read_u16_d16_hi v221, v122 offset:29184
    ds_read_u16_d16_hi v236, v122 offset:45056
    ds_read_u16_d16_hi v237, v122 offset:45568
    ds_read_u16_d16_hi v252, v122 offset:61440
    ds_read_u16_d16_hi v253, v122 offset:61952
    v_accvgpr_write_b32 a128, 0
    v_accvgpr_write_b32 a129, 0
    v_accvgpr_write_b32 a130, 0
    v_accvgpr_write_b32 a131, 0
    ds_read_u16_d16_hi v206, v122 offset:13312
    ds_read_u16_d16_hi v207, v122 offset:13824
    ds_read_u16_d16_hi v222, v122 offset:29696
    ds_read_u16_d16_hi v223, v122 offset:30208
    ds_read_u16_d16_hi v238, v122 offset:46080
    ds_read_u16_d16_hi v239, v122 offset:46592
    ds_read_u16_d16_hi v254, v122 offset:62464
    ds_read_u16_d16_hi v255, v122 offset:62976
    v_accvgpr_write_b32 a132, 0
    v_accvgpr_write_b32 a133, 0
    v_accvgpr_write_b32 a134, 0
    v_accvgpr_write_b32 a135, 0
    buffer_load_dwordx2 v[30:31], v9, s[20:23], 0 offen sc1
    s_waitcnt lgkmcnt(15)
    v_pk_add_f32 v[128:129], v[192:193], v[208:209]
    v_pk_add_f32 v[176:177], v[192:193], v[208:209] neg_lo:[0,1] neg_hi:[0,1]
    v_pk_add_f32 v[144:145], v[224:225], v[240:241]
    v_pk_add_f32 v[160:161], v[224:225], v[240:241] neg_lo:[0,1] neg_hi:[0,1]
    v_fma_f32 v128, v20, v208, v192
    v_fma_f32 v144, v20, v240, v224
    v_mul_f32 v160, v20, v160
    v_mul_f32 v176, v20, v176
    v_fma_f32 v104, v20, v192, v208
    v_mov_b32 v105, v129
    v_fma_f32 v106, v20, v224, v240
    v_mov_b32 v107, v145
    v_pk_add_f32 v[130:131], v[194:195], v[210:211]
    v_pk_add_f32 v[178:179], v[194:195], v[210:211] neg_lo:[0,1] neg_hi:[0,1]
    v_pk_add_f32 v[146:147], v[226:227], v[242:243]
    v_pk_add_f32 v[162:163], v[226:227], v[242:243] neg_lo:[0,1] neg_hi:[0,1]
    v_pk_add_f32 v[132:133], v[196:197], v[212:213]
    v_pk_add_f32 v[180:181], v[196:197], v[212:213] neg_lo:[0,1] neg_hi:[0,1]
    v_pk_add_f32 v[148:149], v[228:229], v[244:245]
    v_pk_add_f32 v[164:165], v[228:229], v[244:245] neg_lo:[0,1] neg_hi:[0,1]
    v_pk_add_f32 v[134:135], v[198:199], v[214:215]
    v_pk_add_f32 v[182:183], v[198:199], v[214:215] neg_lo:[0,1] neg_hi:[0,1]
    v_pk_add_f32 v[150:151], v[230:231], v[246:247]
    v_pk_add_f32 v[166:167], v[230:231], v[246:247] neg_lo:[0,1] neg_hi:[0,1]
    v_pk_add_f32 v[136:137], v[200:201], v[216:217]
    v_pk_add_f32 v[184:185], v[200:201], v[216:217] neg_lo:[0,1] neg_hi:[0,1]
    v_pk_add_f32 v[152:153], v[232:233], v[248:249]
    v_pk_add_f32 v[168:169], v[232:233], v[248:249] neg_lo:[0,1] neg_hi:[0,1]
    v_pk_add_f32 v[138:139], v[202:203], v[218:219]
    v_pk_add_f32 v[186:187], v[202:203], v[218:219] neg_lo:[0,1] neg_hi:[0,1]
    v_pk_add_f32 v[154:155], v[234:235], v[250:251]
    v_pk_add_f32 v[170:171], v[234:235], v[250:251] neg_lo:[0,1] neg_hi:[0,1]
    s_waitcnt lgkmcnt(12)
    v_pk_add_f32 v[140:141], v[204:205], v[220:221]
    v_pk_add_f32 v[188:189], v[204:205], v[220:221] neg_lo:[0,1] neg_hi:[0,1]
    s_waitcnt lgkmcnt(8)
    v_pk_add_f32 v[156:157], v[236:237], v[252:253]
    v_pk_add_f32 v[172:173], v[236:237], v[252:253] neg_lo:[0,1] neg_hi:[0,1]
    s_waitcnt lgkmcnt(4)
    v_pk_add_f32 v[142:143], v[206:207], v[222:223]
    v_pk_add_f32 v[190:191], v[206:207], v[222:223] neg_lo:[0,1] neg_hi:[0,1]
    s_waitcnt lgkmcnt(0)
    v_pk_add_f32 v[158:159], v[238:239], v[254:255]
    v_pk_add_f32 v[174:175], v[238:239], v[254:255] neg_lo:[0,1] neg_hi:[0,1]
    v_mov_b64 v[224:225], v[104:105]
    v_mov_b64 v[226:227], v[106:107]
    v_mov_b64 v[228:229], v[104:105]
    v_mov_b64 v[192:193], v[128:129]
    v_mov_b64 v[194:195], v[130:131]
    v_mov_b64 v[196:197], v[132:133]
    v_mov_b64 v[198:199], v[134:135]
    v_mov_b64 v[200:201], v[136:137]
    v_mov_b64 v[202:203], v[138:139]
    v_mov_b64 v[204:205], v[140:141]
    v_mov_b64 v[206:207], v[142:143]
    v_mov_b64 v[208:209], v[160:161]
    v_mov_b64 v[210:211], v[162:163]
    v_mov_b64 v[212:213], v[164:165]
    v_mov_b64 v[214:215], v[166:167]
    v_mov_b64 v[216:217], v[168:169]
    v_mov_b64 v[218:219], v[170:171]
    v_mov_b64 v[220:221], v[172:173]
    v_mov_b64 v[222:223], v[174:175]
    s_cmp_lg_u32 s42, 0
    s_cbranch_scc1 L_nr7
    v_and_b32 v100, 31, v0
    v_lshlrev_b32 v100, 2, v100
    v_add_u32 v101, 156160, v100
    v_add_u32 v100, 158208, v100
    ds_read2_b32 v[108:109], v101 offset0:0 offset1:32
    ds_read2_b32 v[110:111], v101 offset0:64 offset1:96
    ds_read2_b32 v[112:113], v101 offset0:128 offset1:160
    ds_read2_b32 v[114:115], v101 offset0:192 offset1:224
    v_cvt_f32_u32 v96, v21
    v_sub_f32 v96, 1.0, v96
    s_waitcnt lgkmcnt(0)
    v_fma_f32 v97, v96, v111, v110
    v_fma_f32 v98, v96, v110, v111
    v_sub_f32 v99, v114, v115
    v_mul_f32 v99, v96, v99
    ds_write_b32 v100, v97 offset:0
    ds_write_b32 v100, v99 offset:128
    ds_write_b32 v100, v98 offset:256
    v_fma_f32 v97, v96, v109, v108
    v_fma_f32 v98, v96, v108, v109
    v_sub_f32 v99, v112, v113
    v_mul_f32 v99, v96, v99
    ds_write_b32 v100, v97 offset:384
    ds_write_b32 v100, v99 offset:512
    ds_write_b32 v100, v98 offset:640
    v_lshrrev_b32 v100, 5, v0
    v_lshlrev_b32 v100, 4, v100
    v_add_u32 v100, 158208, v100
    s_mov_b32 exec_lo, 1
    s_mov_b32 exec_hi, 1
    ds_read_b128 v[192:195], v100 offset:0
    ds_read_b128 v[208:211], v100 offset:128
    ds_read_b128 v[196:199], v100 offset:32
    ds_read_b128 v[212:215], v100 offset:160
    ds_read_b128 v[200:203], v100 offset:64
    ds_read_b128 v[216:219], v100 offset:192
    ds_read_b128 v[204:207], v100 offset:96
    ds_read_b128 v[220:223], v100 offset:224
    ds_read_b64 v[228:229], v100 offset:256
    ds_read_b128 v[128:131], v100 offset:384
    ds_read_b128 v[160:163], v100 offset:512
    ds_read_b128 v[132:135], v100 offset:416
    ds_read_b128 v[164:167], v100 offset:544
    ds_read_b128 v[136:139], v100 offset:448
    ds_read_b128 v[168:171], v100 offset:576
    ds_read_b128 v[140:143], v100 offset:480
    ds_read_b128 v[172:175], v100 offset:608
    ds_read_b64 v[224:225], v100 offset:640
    v_mov_b64 v[144:145], 0
    v_mov_b64 v[146:147], 0
    v_mov_b64 v[148:149], 0
    v_mov_b64 v[150:151], 0
    v_mov_b64 v[152:153], 0
    v_mov_b64 v[154:155], 0
    v_mov_b64 v[156:157], 0
    v_mov_b64 v[158:159], 0
    v_mov_b64 v[176:177], 0
    v_mov_b64 v[178:179], 0
    v_mov_b64 v[180:181], 0
    v_mov_b64 v[182:183], 0
    v_mov_b64 v[184:185], 0
    v_mov_b64 v[186:187], 0
    v_mov_b64 v[188:189], 0
    v_mov_b64 v[190:191], 0
    v_mov_b64 v[226:227], 0
    s_waitcnt lgkmcnt(0)
    s_mov_b64 exec, -1
L_nr7:
    s_mov_b32 s68, 100000
    s_waitcnt vmcnt(0)
L_prl:
    v_cmp_ne_u64 vcc, s[40:41], v[30:31]
    s_nop 0
    s_and_b64 exec, exec, vcc
    s_cbranch_scc0 L_prd
    s_sleep 0
    buffer_load_dwordx2 v[30:31], v9, s[20:23], 0 offen sc1
    s_sub_u32 s68, s68, 1
    s_waitcnt vmcnt(0)
    s_cbranch_scc0 L_prl
L_prd:
    s_mov_b64 exec, -1
    s_add_u32 m0, s56, 0
    s_add_u32 s58, s47, 0
    buffer_load_dwordx4 v29, s[20:23], s58 offen sc1 lds
    s_add_u32 m0, s56, 1024
    s_add_u32 s58, s47, 262144
    buffer_load_dwordx4 v29, s[20:23], s58 offen sc1 lds
    s_add_u32 m0, s56, 2048
    s_add_u32 s58, s47, 524288
    buffer_load_dwordx4 v29, s[20:23], s58 offen sc1 lds
    s_add_u32 m0, s56, 3072
    s_add_u32 s58, s47, 786432
    buffer_load_dwordx4 v29, s[20:23], s58 offen sc1 lds
    s_add_u32 m0, s56, 4096
    s_add_u32 s58, s47, 1048576
    buffer_load_dwordx4 v29, s[20:23], s58 offen sc1 lds
    s_add_u32 m0, s56, 5120
    s_add_u32 s58, s47, 1310720
    buffer_load_dwordx4 v29, s[20:23], s58 offen sc1 lds
    s_add_u32 m0, s56, 6144
    s_branch L_ld_p2
.p2align 12
L_st_p2:
L_wP_p2:
    s_branch L_retP
L_ld_p2:
    s_add_u32 s58, s47, 1572864
    buffer_load_dwordx4 v29, s[20:23], s58 offen sc1 lds
    s_add_u32 m0, s56, 7168
    s_add_u32 s58, s47, 1835008
    buffer_load_dwordx4 v29, s[20:23], s58 offen sc1 lds
    ds_read_u16_d16_hi a184, v122 offset:2
    ds_read_u16_d16_hi a185, v122 offset:514
    ds_read_u16_d16_hi a200, v122 offset:16386
    ds_read_u16_d16_hi a201, v122 offset:16898
    ds_read_u16_d16_hi a216, v122 offset:32770
    ds_read_u16_d16_hi a217, v122 offset:33282
    ds_read_u16_d16_hi a232, v122 offset:49154
    ds_read_u16_d16_hi a233, v122 offset:49666
    ds_read_u16_d16_hi a186, v122 offset:1026
    ds_read_u16_d16_hi a187, v122 offset:1538
    ds_read_u16_d16_hi a202, v122 offset:17410
    ds_read_u16_d16_hi a203, v122 offset:17922
    ds_read_u16_d16_hi a218, v122 offset:33794
    ds_read_u16_d16_hi a219, v122 offset:34306
    ds_read_u16_d16_hi a234, v122 offset:50178
    ds_read_u16_d16_hi a235, v122 offset:50690
    ds_read_u16_d16_hi a188, v122 offset:4098
    ds_read_u16_d16_hi a189, v122 offset:4610
    ds_read_u16_d16_hi a204, v122 offset:20482
    ds_read_u16_d16_hi a205, v122 offset:20994
    ds_read_u16_d16_hi a220, v122 offset:36866
    ds_read_u16_d16_hi a221, v122 offset:37378
    ds_read_u16_d16_hi a236, v122 offset:53250
    ds_read_u16_d16_hi a237, v122 offset:53762
    ds_read_u16_d16_hi a190, v122 offset:5122
    ds_read_u16_d16_hi a191, v122 offset:5634
    ds_read_u16_d16_hi a206, v122 offset:21506
    ds_read_u16_d16_hi a207, v122 offset:22018
    ds_read_u16_d16_hi a222, v122 offset:37890
    ds_read_u16_d16_hi a223, v122 offset:38402
    ds_read_u16_d16_hi a238, v122 offset:54274
    ds_read_u16_d16_hi a239, v122 offset:54786
    ds_read_u16_d16_hi a192, v122 offset:8194
    ds_read_u16_d16_hi a193, v122 offset:8706
    ds_read_u16_d16_hi a208, v122 offset:24578
    ds_read_u16_d16_hi a209, v122 offset:25090
    ds_read_u16_d16_hi a224, v122 offset:40962
    ds_read_u16_d16_hi a225, v122 offset:41474
    ds_read_u16_d16_hi a128, v122 offset:57346
    ds_read_u16_d16_hi a129, v122 offset:57858
    ds_read_u16_d16_hi a194, v122 offset:9218
    ds_read_u16_d16_hi a195, v122 offset:9730
    ds_read_u16_d16_hi a210, v122 offset:25602
    ds_read_u16_d16_hi a211, v122 offset:26114
    ds_read_u16_d16_hi a226, v122 offset:41986
    ds_read_u16_d16_hi a227, v122 offset:42498
    ds_read_u16_d16_hi a130, v122 offset:58370
    ds_read_u16_d16_hi a131, v122 offset:58882
    ds_read_u16_d16_hi a196, v122 offset:12290
    ds_read_u16_d16_hi a197, v122 offset:12802
    ds_read_u16_d16_hi a212, v122 offset:28674
    ds_read_u16_d16_hi a213, v122 offset:29186
    ds_read_u16_d16_hi a228, v122 offset:45058
    ds_read_u16_d16_hi a229, v122 offset:45570
    ds_read_u16_d16_hi a132, v122 offset:61442
    ds_read_u16_d16_hi a133, v122 offset:61954
    ds_read_u16_d16_hi a198, v122 offset:13314
    ds_read_u16_d16_hi a199, v122 offset:13826
    ds_read_u16_d16_hi a214, v122 offset:29698
    ds_read_u16_d16_hi a215, v122 offset:30210
    ds_read_u16_d16_hi a230, v122 offset:46082
    ds_read_u16_d16_hi a231, v122 offset:46594
    ds_read_u16_d16_hi a134, v122 offset:62466
    ds_read_u16_d16_hi a135, v122 offset:62978
    s_add_u32 m0, s56, 8192
    s_add_u32 s58, s47, 8192
    buffer_load_dwordx4 v29, s[20:23], s58 offen sc1 lds
    v_lshrrev_b32 v26, 5, v0
    v_lshlrev_b32 v26, 9, v26
    v_bfe_u32 v96, v0, 2, 2
    v_lshl_add_u32 v26, v96, 7, v26
    s_add_u32 m0, s56, 9216
    s_add_u32 s58, s47, 270336
    buffer_load_dwordx4 v29, s[20:23], s58 offen sc1 lds
    v_bfe_u32 v96, v0, 4, 1
    v_lshl_add_u32 v26, v96, 5, v26
    v_and_b32 v96, 3, v0
    v_lshl_add_u32 v26, v96, 3, v26
    s_add_u32 m0, s56, 10240
    s_add_u32 s58, s47, 532480
    buffer_load_dwordx4 v29, s[20:23], s58 offen sc1 lds
    v_bfe_u32 v96, v0, 3, 1
    v_lshl_add_u32 v26, v96, 6, v26
    v_add_u32 v26, s56, v26
    v_xor_b32 v27, 64, v26
    s_waitcnt lgkmcnt(0)
    s_barrier
    s_waitcnt vmcnt(3)
    ds_read_b64_tr_b16 v[96:97], v26 offset:0
    ds_read_b64_tr_b16 v[98:99], v26 offset:1024
    ds_read_b64_tr_b16 v[100:101], v27 offset:0
    ds_read_b64_tr_b16 v[102:103], v27 offset:1024
    ds_read_b64_tr_b16 v[104:105], v26 offset:2048
    ds_read_b64_tr_b16 v[106:107], v26 offset:3072
    ds_read_b64_tr_b16 v[108:109], v27 offset:2048
    ds_read_b64_tr_b16 v[110:111], v27 offset:3072
    ds_read_b64_tr_b16 v[112:113], v26 offset:4096
    ds_read_b64_tr_b16 v[114:115], v26 offset:5120
    ds_read_b64_tr_b16 v[116:117], v27 offset:4096
    ds_read_b64_tr_b16 v[118:119], v27 offset:5120
    ds_read_b64_tr_b16 v[120:121], v26 offset:6144
    ds_read_b64_tr_b16 v[122:123], v26 offset:7168
    ds_read_b64_tr_b16 v[124:125], v27 offset:6144
    ds_read_b64_tr_b16 v[126:127], v27 offset:7168
    s_waitcnt lgkmcnt(12)
    v_mfma_f32_32x32x16_bf16 v[32:47], a[136:139], v[96:99], 0
    s_add_u32 m0, s56, 11264
    s_add_u32 s58, s47, 794624
    buffer_load_dwordx4 v29, s[20:23], s58 offen sc1 lds
    v_and_b32 v232, 31, v0
    v_lshrrev_b32 v233, 5, v0
    v_mfma_f32_32x32x16_bf16 v[48:63], a[136:139], v[100:103], 0
    s_add_u32 m0, s56, 12288
    s_add_u32 s58, s47, 1056768
    v_and_b32 v234, 7, v0
    v_xor_b32 v233, v233, v234
    v_lshlrev_b32 v233, 4, v233
    v_lshl_add_u32 v233, v232, 7, v233
    v_mfma_f32_32x32x16_bf16 v[64:79], a[140:143], v[96:99], 0
    buffer_load_dwordx4 v29, s[20:23], s58 offen sc1 lds
    v_add_u32 v12, s56, v233
    v_xor_b32 v13, 32, v12
    v_xor_b32 v14, 64, v12
    v_xor_b32 v15, 96, v12
    v_mfma_f32_32x32x16_bf16 v[80:95], a[140:143], v[100:103], 0
    s_add_u32 m0, s56, 13312
    s_add_u32 s58, s47, 1318912
    s_lshl_b32 s39, s43, 1
    v_lshrrev_b32 v235, 3, v0
    v_xor_b32 v232, s39, v0
    s_waitcnt lgkmcnt(8)
    v_mfma_f32_32x32x16_bf16 v[32:47], a[152:155], v[104:107], v[32:47]
    buffer_load_dwordx4 v29, s[20:23], s58 offen sc1 lds
    v_xor_b32 v232, v232, v235
    v_and_b32 v232, 7, v232
    v_lshlrev_b32 v232, 4, v232
    v_lshl_add_u32 v232, v235, 7, v232
    v_mfma_f32_32x32x16_bf16 v[48:63], a[152:155], v[108:111], v[48:63]
    s_add_u32 m0, s56, 14336
    s_add_u32 s58, s47, 1581056
    v_add_u32 v16, s56, v232
    v_xor_b32 v17, 16, v16
    v_lshlrev_b32 v234, 4, v234
    v_lshl_add_u32 v18, v235, 16, v234
    v_mfma_f32_32x32x16_bf16 v[64:79], a[156:159], v[104:107], v[64:79]
    buffer_load_dwordx4 v29, s[20:23], s58 offen sc1 lds
    s_bfe_u32 s59, s43, 0x10002
    s_xor_b32 s59, s59, s49
    s_lshl_b32 s59, s59, 7
    s_lshl_b32 s39, s48, 15
    v_mfma_f32_32x32x16_bf16 v[80:95], a[156:159], v[108:111], v[80:95]
    s_add_u32 m0, s56, 15360
    s_add_u32 s58, s47, 1843200
    s_add_u32 s39, s39, s59
    s_lshl_b32 s59, s43, 9
    s_add_u32 s39, s39, s59
    s_waitcnt lgkmcnt(4)
    v_mfma_f32_32x32x16_bf16 v[32:47], a[168:171], v[112:115], v[32:47]
    buffer_load_dwordx4 v29, s[20:23], s58 offen sc1 lds
    s_add_u32 s39, s39, 3145728
    v_mfma_f32_32x32x16_bf16 v[48:63], a[168:171], v[116:119], v[48:63]
    v_mfma_f32_32x32x16_bf16 v[64:79], a[172:175], v[112:115], v[64:79]
    s_add_u32 m0, s56, 65536
    s_mul_i32 s15, s64, 14336
    s_add_u32 s15, s15, s32
    s_add_u32 s37, s15, s8
    buffer_load_dwordx4 v1, s[20:23], s37 offen offset:0 sc1 lds
    buffer_load_dwordx4 v1, s[20:23], s37 offen offset:1024 sc1 lds
    v_mfma_f32_32x32x16_bf16 v[80:95], a[172:175], v[116:119], v[80:95]
    s_waitcnt lgkmcnt(0)
    v_mfma_f32_32x32x16_bf16 v[32:47], a[240:243], v[120:123], v[32:47]
    s_add_u32 m0, s56, 67584
    s_add_u32 s37, s15, s9
    buffer_load_dwordx4 v1, s[20:23], s37 offen offset:0 sc1 lds
    buffer_load_dwordx4 v1, s[20:23], s37 offen offset:1024 sc1 lds
    v_mfma_f32_32x32x16_bf16 v[48:63], a[240:243], v[124:127], v[48:63]
    v_mfma_f32_32x32x16_bf16 v[64:79], a[244:247], v[120:123], v[64:79]
    v_mfma_f32_32x32x16_bf16 v[80:95], a[244:247], v[124:127], v[80:95]
    s_nop 4
    v_pk_mul_f32 v[232:233], v[32:33], v[128:129]
    s_nop 3
    v_pk_mul_f32 v[234:235], v[48:49], v[192:193]
    s_add_u32 m0, s56, 69632
    s_add_u32 s37, s15, s10
    buffer_load_dwordx4 v1, s[20:23], s37 offen offset:0 sc1 lds
    buffer_load_dwordx4 v1, s[20:23], s37 offen offset:1024 sc1 lds
    v_pk_mul_f32 v[236:237], v[64:65], v[224:225]
    v_pk_mul_f32 v[238:239], v[80:81], v[228:229]
    v_pk_fma_f32 v[232:233], v[48:49], v[144:145], v[232:233]
    v_pk_fma_f32 v[234:235], v[32:33], v[144:145], v[234:235] neg_lo:[1,0,0] neg_hi:[1,0,0]
    v_pk_fma_f32 v[236:237], v[80:81], v[226:227], v[236:237]
    v_pk_fma_f32 v[238:239], v[64:65], v[226:227], v[238:239] neg_lo:[1,0,0] neg_hi:[1,0,0]
    v_pk_fma_f32 v[232:233], v[64:65], v[160:161], v[232:233]
    v_pk_fma_f32 v[234:235], v[80:81], v[208:209], v[234:235]
    v_pk_fma_f32 v[236:237], v[32:33], v[160:161], v[236:237] neg_lo:[1,0,0] neg_hi:[1,0,0]
    v_pk_fma_f32 v[238:239], v[48:49], v[208:209], v[238:239] neg_lo:[1,0,0] neg_hi:[1,0,0]
    v_pk_fma_f32 v[232:233], v[80:81], v[176:177], v[232:233] neg_lo:[1,0,0] neg_hi:[1,0,0]
    v_pk_fma_f32 v[234:235], v[64:65], v[176:177], v[234:235]
    v_pk_fma_f32 v[236:237], v[48:49], v[176:177], v[236:237]
    v_pk_fma_f32 v[238:239], v[32:33], v[176:177], v[238:239] neg_lo:[1,0,0] neg_hi:[1,0,0]
    s_add_u32 m0, s56, 71680
    s_add_u32 s37, s15, s11
    buffer_load_dwordx4 v1, s[20:23], s37 offen offset:0 sc1 lds
    buffer_load_dwordx4 v1, s[20:23], s37 offen offset:1024 sc1 lds
    v_cvt_pk_bf16_f32 v96, v232, v236
    v_cvt_pk_bf16_f32 v97, v233, v237
    v_cvt_pk_bf16_f32 v112, v234, v238
    v_cvt_pk_bf16_f32 v113, v235, v239
    v_pk_mul_f32 v[240:241], v[34:35], v[130:131]
    v_pk_mul_f32 v[242:243], v[50:51], v[194:195]
    v_pk_mul_f32 v[244:245], v[66:67], v[130:131]
    v_pk_mul_f32 v[246:247], v[82:83], v[194:195]
    v_pk_fma_f32 v[240:241], v[50:51], v[146:147], v[240:241]
    v_pk_fma_f32 v[242:243], v[34:35], v[146:147], v[242:243] neg_lo:[1,0,0] neg_hi:[1,0,0]
    v_pk_fma_f32 v[244:245], v[82:83], v[146:147], v[244:245]
    v_pk_fma_f32 v[246:247], v[66:67], v[146:147], v[246:247] neg_lo:[1,0,0] neg_hi:[1,0,0]
    v_pk_fma_f32 v[240:241], v[66:67], v[162:163], v[240:241]
    v_pk_fma_f32 v[242:243], v[82:83], v[210:211], v[242:243]
    s_add_u32 m0, s56, 73728
    s_add_u32 s37, s15, s12
    buffer_load_dwordx4 v1, s[20:23], s37 offen offset:0 sc1 lds
    buffer_load_dwordx4 v1, s[20:23], s37 offen offset:1024 sc1 lds
    v_pk_fma_f32 v[244:245], v[34:35], v[162:163], v[244:245] neg_lo:[1,0,0] neg_hi:[1,0,0]
    v_pk_fma_f32 v[246:247], v[50:51], v[210:211], v[246:247] neg_lo:[1,0,0] neg_hi:[1,0,0]
    v_pk_fma_f32 v[240:241], v[82:83], v[178:179], v[240:241] neg_lo:[1,0,0] neg_hi:[1,0,0]
    v_pk_fma_f32 v[242:243], v[66:67], v[178:179], v[242:243]
    v_pk_fma_f32 v[244:245], v[50:51], v[178:179], v[244:245]
    v_pk_fma_f32 v[246:247], v[34:35], v[178:179], v[246:247] neg_lo:[1,0,0] neg_hi:[1,0,0]
    v_cvt_pk_bf16_f32 v98, v240, v244
    v_cvt_pk_bf16_f32 v99, v241, v245
    v_cvt_pk_bf16_f32 v114, v242, v246
    v_cvt_pk_bf16_f32 v115, v243, v247
    v_pk_mul_f32 v[232:233], v[36:37], v[132:133]
    v_pk_mul_f32 v[234:235], v[52:53], v[196:197]
    v_pk_mul_f32 v[236:237], v[68:69], v[132:133]
    v_pk_mul_f32 v[238:239], v[84:85], v[196:197]
    s_add_u32 m0, s56, 75776
    s_add_u32 s37, s15, s13
    buffer_load_dwordx4 v1, s[20:23], s37 offen offset:0 sc1 lds
    buffer_load_dwordx4 v1, s[20:23], s37 offen offset:1024 sc1 lds
    v_pk_fma_f32 v[232:233], v[52:53], v[148:149], v[232:233]
    v_pk_fma_f32 v[234:235], v[36:37], v[148:149], v[234:235] neg_lo:[1,0,0] neg_hi:[1,0,0]
    v_pk_fma_f32 v[236:237], v[84:85], v[148:149], v[236:237]
    v_pk_fma_f32 v[238:239], v[68:69], v[148:149], v[238:239] neg_lo:[1,0,0] neg_hi:[1,0,0]
    v_pk_fma_f32 v[232:233], v[68:69], v[164:165], v[232:233]
    v_pk_fma_f32 v[234:235], v[84:85], v[212:213], v[234:235]
    v_pk_fma_f32 v[236:237], v[36:37], v[164:165], v[236:237] neg_lo:[1,0,0] neg_hi:[1,0,0]
    v_pk_fma_f32 v[238:239], v[52:53], v[212:213], v[238:239] neg_lo:[1,0,0] neg_hi:[1,0,0]
    v_pk_fma_f32 v[232:233], v[84:85], v[180:181], v[232:233] neg_lo:[1,0,0] neg_hi:[1,0,0]
    v_pk_fma_f32 v[234:235], v[68:69], v[180:181], v[234:235]
    v_pk_fma_f32 v[236:237], v[52:53], v[180:181], v[236:237]
    v_pk_fma_f32 v[238:239], v[36:37], v[180:181], v[238:239] neg_lo:[1,0,0] neg_hi:[1,0,0]
    v_cvt_pk_bf16_f32 v100, v232, v236
    v_cvt_pk_bf16_f32 v101, v233, v237
    s_add_u32 m0, s56, 77824
    s_add_u32 s37, s15, s14
    buffer_load_dwordx4 v1, s[20:23], s37 offen offset:0 sc1 lds
    buffer_load_dwordx4 v1, s[20:23], s37 offen offset:1024 sc1 lds
    v_cvt_pk_bf16_f32 v116, v234, v238
    v_cvt_pk_bf16_f32 v117, v235, v239
    v_pk_mul_f32 v[240:241], v[38:39], v[134:135]
    v_pk_mul_f32 v[242:243], v[54:55], v[198:199]
    v_pk_mul_f32 v[244:245], v[70:71], v[134:135]
    v_pk_mul_f32 v[246:247], v[86:87], v[198:199]
    v_pk_fma_f32 v[240:241], v[54:55], v[150:151], v[240:241]
    v_pk_fma_f32 v[242:243], v[38:39], v[150:151], v[242:243] neg_lo:[1,0,0] neg_hi:[1,0,0]
    v_pk_fma_f32 v[244:245], v[86:87], v[150:151], v[244:245]
    v_pk_fma_f32 v[246:247], v[70:71], v[150:151], v[246:247] neg_lo:[1,0,0] neg_hi:[1,0,0]
    v_pk_fma_f32 v[240:241], v[70:71], v[166:167], v[240:241]
    v_pk_fma_f32 v[242:243], v[86:87], v[214:215], v[242:243]
    v_pk_fma_f32 v[244:245], v[38:39], v[166:167], v[244:245] neg_lo:[1,0,0] neg_hi:[1,0,0]
    v_pk_fma_f32 v[246:247], v[54:55], v[214:215], v[246:247] neg_lo:[1,0,0] neg_hi:[1,0,0]
    s_add_u32 m0, s56, 79872
    s_mul_i32 s15, s65, 14336
    s_add_u32 s15, s15, s32
    s_add_u32 s37, s15, s8
    buffer_load_dwordx4 v1, s[20:23], s37 offen offset:0 sc1 lds
    buffer_load_dwordx4 v1, s[20:23], s37 offen offset:1024 sc1 lds
    v_pk_fma_f32 v[240:241], v[86:87], v[182:183], v[240:241] neg_lo:[1,0,0] neg_hi:[1,0,0]
    v_pk_fma_f32 v[242:243], v[70:71], v[182:183], v[242:243]
    v_pk_fma_f32 v[244:245], v[54:55], v[182:183], v[244:245]
    v_pk_fma_f32 v[246:247], v[38:39], v[182:183], v[246:247] neg_lo:[1,0,0] neg_hi:[1,0,0]
    v_cvt_pk_bf16_f32 v102, v240, v244
    v_cvt_pk_bf16_f32 v103, v241, v245
    v_cvt_pk_bf16_f32 v118, v242, v246
    v_cvt_pk_bf16_f32 v119, v243, v247
    v_pk_mul_f32 v[232:233], v[40:41], v[136:137]
    v_pk_mul_f32 v[234:235], v[56:57], v[200:201]
    v_pk_mul_f32 v[236:237], v[72:73], v[136:137]
    v_pk_mul_f32 v[238:239], v[88:89], v[200:201]
    v_pk_fma_f32 v[232:233], v[56:57], v[152:153], v[232:233]
    v_pk_fma_f32 v[234:235], v[40:41], v[152:153], v[234:235] neg_lo:[1,0,0] neg_hi:[1,0,0]
    s_mul_i32 s15, s65, 14336
    s_add_u32 s15, s15, s32
    s_add_u32 s37, s15, s13
    buffer_load_dwordx4 a[0:3], v1, s[20:23], s37 offen offset:0 sc1
    v_pk_fma_f32 v[236:237], v[88:89], v[152:153], v[236:237]
    v_pk_fma_f32 v[238:239], v[72:73], v[152:153], v[238:239] neg_lo:[1,0,0] neg_hi:[1,0,0]
    v_pk_fma_f32 v[232:233], v[72:73], v[168:169], v[232:233]
    v_pk_fma_f32 v[234:235], v[88:89], v[216:217], v[234:235]
    v_pk_fma_f32 v[236:237], v[40:41], v[168:169], v[236:237] neg_lo:[1,0,0] neg_hi:[1,0,0]
    v_pk_fma_f32 v[238:239], v[56:57], v[216:217], v[238:239] neg_lo:[1,0,0] neg_hi:[1,0,0]
    v_pk_fma_f32 v[232:233], v[88:89], v[184:185], v[232:233] neg_lo:[1,0,0] neg_hi:[1,0,0]
    v_pk_fma_f32 v[234:235], v[72:73], v[184:185], v[234:235]
    v_pk_fma_f32 v[236:237], v[56:57], v[184:185], v[236:237]
    v_pk_fma_f32 v[238:239], v[40:41], v[184:185], v[238:239] neg_lo:[1,0,0] neg_hi:[1,0,0]
    v_cvt_pk_bf16_f32 v104, v232, v236
    v_cvt_pk_bf16_f32 v105, v233, v237
    v_cvt_pk_bf16_f32 v120, v234, v238
    v_cvt_pk_bf16_f32 v121, v235, v239
    buffer_load_dwordx4 a[4:7], v1, s[20:23], s37 offen offset:1024 sc1
    v_pk_mul_f32 v[240:241], v[42:43], v[138:139]
    v_pk_mul_f32 v[242:243], v[58:59], v[202:203]
    v_pk_mul_f32 v[244:245], v[74:75], v[138:139]
    v_pk_mul_f32 v[246:247], v[90:91], v[202:203]
    v_pk_fma_f32 v[240:241], v[58:59], v[154:155], v[240:241]
    v_pk_fma_f32 v[242:243], v[42:43], v[154:155], v[242:243] neg_lo:[1,0,0] neg_hi:[1,0,0]
    v_pk_fma_f32 v[244:245], v[90:91], v[154:155], v[244:245]
    v_pk_fma_f32 v[246:247], v[74:75], v[154:155], v[246:247] neg_lo:[1,0,0] neg_hi:[1,0,0]
    v_pk_fma_f32 v[240:241], v[74:75], v[170:171], v[240:241]
    v_pk_fma_f32 v[242:243], v[90:91], v[218:219], v[242:243]
    v_pk_fma_f32 v[244:245], v[42:43], v[170:171], v[244:245] neg_lo:[1,0,0] neg_hi:[1,0,0]
    v_pk_fma_f32 v[246:247], v[58:59], v[218:219], v[246:247] neg_lo:[1,0,0] neg_hi:[1,0,0]
    v_pk_fma_f32 v[240:241], v[90:91], v[186:187], v[240:241] neg_lo:[1,0,0] neg_hi:[1,0,0]
    v_pk_fma_f32 v[242:243], v[74:75], v[186:187], v[242:243]
    s_add_u32 s37, s15, s14
    buffer_load_dwordx4 a[8:11], v1, s[20:23], s37 offen offset:0 sc1
    v_pk_fma_f32 v[244:245], v[58:59], v[186:187], v[244:245]
    v_pk_fma_f32 v[246:247], v[42:43], v[186:187], v[246:247] neg_lo:[1,0,0] neg_hi:[1,0,0]
    v_cvt_pk_bf16_f32 v106, v240, v244
    v_cvt_pk_bf16_f32 v107, v241, v245
    v_cvt_pk_bf16_f32 v122, v242, v246
    v_cvt_pk_bf16_f32 v123, v243, v247
    v_pk_mul_f32 v[232:233], v[44:45], v[140:141]
    v_pk_mul_f32 v[234:235], v[60:61], v[204:205]
    v_pk_mul_f32 v[236:237], v[76:77], v[140:141]
    v_pk_mul_f32 v[238:239], v[92:93], v[204:205]
    v_pk_fma_f32 v[232:233], v[60:61], v[156:157], v[232:233]
    v_pk_fma_f32 v[234:235], v[44:45], v[156:157], v[234:235] neg_lo:[1,0,0] neg_hi:[1,0,0]
    v_pk_fma_f32 v[236:237], v[92:93], v[156:157], v[236:237]
    v_pk_fma_f32 v[238:239], v[76:77], v[156:157], v[238:239] neg_lo:[1,0,0] neg_hi:[1,0,0]
    s_mul_i32 s15, s65, 14336
    s_add_u32 s15, s15, s32
    s_add_u32 s37, s15, s14
    buffer_load_dwordx4 a[12:15], v1, s[20:23], s37 offen offset:1024 sc1
    v_pk_fma_f32 v[232:233], v[76:77], v[172:173], v[232:233]
    v_pk_fma_f32 v[234:235], v[92:93], v[220:221], v[234:235]
    v_pk_fma_f32 v[236:237], v[44:45], v[172:173], v[236:237] neg_lo:[1,0,0] neg_hi:[1,0,0]
    v_pk_fma_f32 v[238:239], v[60:61], v[220:221], v[238:239] neg_lo:[1,0,0] neg_hi:[1,0,0]
    v_pk_fma_f32 v[232:233], v[92:93], v[188:189], v[232:233] neg_lo:[1,0,0] neg_hi:[1,0,0]
    v_pk_fma_f32 v[234:235], v[76:77], v[188:189], v[234:235]
    v_pk_fma_f32 v[236:237], v[60:61], v[188:189], v[236:237]
    v_pk_fma_f32 v[238:239], v[44:45], v[188:189], v[238:239] neg_lo:[1,0,0] neg_hi:[1,0,0]
    v_cvt_pk_bf16_f32 v108, v232, v236
    v_cvt_pk_bf16_f32 v109, v233, v237
    v_cvt_pk_bf16_f32 v124, v234, v238
    v_cvt_pk_bf16_f32 v125, v235, v239
    v_pk_mul_f32 v[240:241], v[46:47], v[142:143]
    v_pk_mul_f32 v[242:243], v[62:63], v[206:207]
    v_pk_mul_f32 v[244:245], v[78:79], v[142:143]
    v_pk_mul_f32 v[246:247], v[94:95], v[206:207]
    v_pk_fma_f32 v[240:241], v[62:63], v[158:159], v[240:241]
    v_pk_fma_f32 v[242:243], v[46:47], v[158:159], v[242:243] neg_lo:[1,0,0] neg_hi:[1,0,0]
    v_pk_fma_f32 v[244:245], v[94:95], v[158:159], v[244:245]
    v_pk_fma_f32 v[246:247], v[78:79], v[158:159], v[246:247] neg_lo:[1,0,0] neg_hi:[1,0,0]
    v_pk_fma_f32 v[240:241], v[78:79], v[174:175], v[240:241]
    v_pk_fma_f32 v[242:243], v[94:95], v[222:223], v[242:243]
    v_pk_fma_f32 v[244:245], v[46:47], v[174:175], v[244:245] neg_lo:[1,0,0] neg_hi:[1,0,0]
    v_pk_fma_f32 v[246:247], v[62:63], v[222:223], v[246:247] neg_lo:[1,0,0] neg_hi:[1,0,0]
    v_pk_fma_f32 v[240:241], v[94:95], v[190:191], v[240:241] neg_lo:[1,0,0] neg_hi:[1,0,0]
    v_pk_fma_f32 v[242:243], v[78:79], v[190:191], v[242:243]
    v_pk_fma_f32 v[244:245], v[62:63], v[190:191], v[244:245]
    v_pk_fma_f32 v[246:247], v[46:47], v[190:191], v[246:247] neg_lo:[1,0,0] neg_hi:[1,0,0]
    v_cvt_pk_bf16_f32 v110, v240, v244
    v_cvt_pk_bf16_f32 v111, v241, v245
    v_cvt_pk_bf16_f32 v126, v242, v246
    v_cvt_pk_bf16_f32 v127, v243, v247
    s_waitcnt vmcnt(20)
    v_mfma_f32_32x32x16_bf16 v[32:47], v[96:99], a[144:147], 0
    s_mul_i32 s15, s66, 14336
    s_add_u32 s15, s15, s32
    s_add_u32 s37, s15, s8
    buffer_load_dwordx4 a[72:75], v1, s[20:23], s37 offen offset:0 sc1
    v_accvgpr_read_b32 v128, a184
    v_mfma_f32_32x32x16_bf16 v[32:47], v[100:103], a[160:163], v[32:47]
    v_accvgpr_read_b32 v230, a200
    v_accvgpr_read_b32 v144, a216
    v_accvgpr_read_b32 v231, a232
    v_sub_f32 v176, v128, v230
    v_fma_f32 v224, v20, v128, v230
    v_mul_f32 v176, v20, v176
    v_mfma_f32_32x32x16_bf16 v[32:47], v[104:107], a[176:179], v[32:47]
    v_fmac_f32 v128, v20, v230
    v_sub_f32 v160, v144, v231
    v_fma_f32 v226, v20, v144, v231
    v_mul_f32 v160, v20, v160
    v_fmac_f32 v144, v20, v231
    v_accvgpr_read_b32 v129, a185
    v_mfma_f32_32x32x16_bf16 v[32:47], v[108:111], a[248:251], v[32:47]
    v_accvgpr_read_b32 v230, a201
    v_accvgpr_read_b32 v145, a217
    v_accvgpr_read_b32 v231, a233
    v_sub_f32 v177, v129, v230
    v_add_f32 v129, v129, v230
    v_mov_b32 v225, v129
    v_mfma_f32_32x32x16_bf16 v[48:63], v[112:115], a[144:147], 0
    buffer_load_dwordx4 a[76:79], v1, s[20:23], s37 offen offset:1024 sc1
    v_sub_f32 v161, v145, v231
    v_add_f32 v145, v145, v231
    v_mov_b32 v227, v145
    v_accvgpr_read_b32 v130, a186
    v_mfma_f32_32x32x16_bf16 v[48:63], v[116:119], a[160:163], v[48:63]
    v_cvt_pk_bf16_f32 v248, v32, v33
    v_cvt_pk_bf16_f32 v249, v34, v35
    v_cvt_pk_bf16_f32 v250, v36, v37
    v_cvt_pk_bf16_f32 v251, v38, v39
    v_accvgpr_read_b32 v230, a202
    v_accvgpr_read_b32 v146, a218
    v_mfma_f32_32x32x16_bf16 v[48:63], v[120:123], a[176:179], v[48:63]
    ds_write_b128 v12, v[248:251] offset:0
    v_accvgpr_read_b32 v231, a234
    v_mfma_f32_32x32x16_bf16 v[48:63], v[124:127], a[248:251], v[48:63]
    v_cvt_pk_bf16_f32 v252, v40, v41
    v_cvt_pk_bf16_f32 v253, v42, v43
    v_cvt_pk_bf16_f32 v254, v44, v45
    v_cvt_pk_bf16_f32 v255, v46, v47
    v_sub_f32 v178, v130, v230
    v_add_f32 v130, v130, v230
    v_mfma_f32_32x32x16_bf16 v[64:79], v[96:99], a[148:151], 0
    ds_write_b128 v13, v[252:255] offset:0
    v_sub_f32 v162, v146, v231
    v_mfma_f32_32x32x16_bf16 v[64:79], v[100:103], a[164:167], v[64:79]
    s_add_u32 s37, s15, s9
    s_nop 0
    v_cvt_pk_bf16_f32 v248, v48, v49
    v_cvt_pk_bf16_f32 v249, v50, v51
    v_cvt_pk_bf16_f32 v250, v52, v53
    v_cvt_pk_bf16_f32 v251, v54, v55
    v_add_f32 v146, v146, v231
    v_mfma_f32_32x32x16_bf16 v[64:79], v[104:107], a[180:183], v[64:79]
    ds_write_b128 v14, v[248:251] offset:0
    v_accvgpr_read_b32 v131, a187
    v_mfma_f32_32x32x16_bf16 v[64:79], v[108:111], a[252:255], v[64:79]
    v_cvt_pk_bf16_f32 v252, v56, v57
    v_cvt_pk_bf16_f32 v253, v58, v59
    v_cvt_pk_bf16_f32 v254, v60, v61
    v_cvt_pk_bf16_f32 v255, v62, v63
    v_accvgpr_read_b32 v230, a203
    v_accvgpr_read_b32 v147, a219
    v_mfma_f32_32x32x16_bf16 v[80:95], v[112:115], a[148:151], 0
    ds_write_b128 v15, v[252:255] offset:0
    v_accvgpr_read_b32 v231, a235
    v_mfma_f32_32x32x16_bf16 v[80:95], v[116:119], a[164:167], v[80:95]
    s_nop 1
    v_cvt_pk_bf16_f32 v248, v64, v65
    v_cvt_pk_bf16_f32 v249, v66, v67
    v_cvt_pk_bf16_f32 v250, v68, v69
    v_cvt_pk_bf16_f32 v251, v70, v71
    v_sub_f32 v179, v131, v230
    v_add_f32 v131, v131, v230
    v_mfma_f32_32x32x16_bf16 v[80:95], v[120:123], a[180:183], v[80:95]
    ds_write_b128 v12, v[248:251] offset:4096
    v_cvt_pk_bf16_f32 v252, v72, v73
    v_mfma_f32_32x32x16_bf16 v[80:95], v[124:127], a[252:255], v[80:95]
    buffer_load_dwordx4 a[80:83], v1, s[20:23], s37 offen offset:0 sc1
    buffer_load_dwordx4 a[84:87], v1, s[20:23], s37 offen offset:1024 sc1
    s_add_u32 s37, s15, s10
    buffer_load_dwordx4 a[88:91], v1, s[20:23], s37 offen offset:0 sc1
    buffer_load_dwordx4 a[92:95], v1, s[20:23], s37 offen offset:1024 sc1
    s_add_u32 s37, s15, s11
    buffer_load_dwordx4 a[96:99], v1, s[20:23], s37 offen offset:0 sc1
    v_cvt_pk_bf16_f32 v253, v74, v75
    v_cvt_pk_bf16_f32 v254, v76, v77
    v_cvt_pk_bf16_f32 v255, v78, v79
    ds_write_b128 v13, v[252:255] offset:4096
    ds_read_b64_tr_b16 v[96:97], v26 offset:8192
    ds_read_b64_tr_b16 v[98:99], v26 offset:9216
    ds_read_b64_tr_b16 v[100:101], v27 offset:8192
    ds_read_b64_tr_b16 v[102:103], v27 offset:9216
    ds_read_b64_tr_b16 v[104:105], v26 offset:10240
    ds_read_b64_tr_b16 v[106:107], v26 offset:11264
    ds_read_b64_tr_b16 v[108:109], v27 offset:10240
    ds_read_b64_tr_b16 v[110:111], v27 offset:11264
    ds_read_b64_tr_b16 v[112:113], v26 offset:12288
    ds_read_b64_tr_b16 v[114:115], v26 offset:13312
    ds_read_b64_tr_b16 v[116:117], v27 offset:12288
    ds_read_b64_tr_b16 v[118:119], v27 offset:13312
    ds_read_b64_tr_b16 v[120:121], v26 offset:14336
    ds_read_b64_tr_b16 v[122:123], v26 offset:15360
    ds_read_b64_tr_b16 v[124:125], v27 offset:14336
    ds_read_b64_tr_b16 v[126:127], v27 offset:15360
    v_cvt_pk_bf16_f32 v248, v80, v81
    v_cvt_pk_bf16_f32 v249, v82, v83
    v_cvt_pk_bf16_f32 v250, v84, v85
    v_cvt_pk_bf16_f32 v251, v86, v87
    ds_write_b128 v14, v[248:251] offset:4096
    v_cvt_pk_bf16_f32 v252, v88, v89
    v_cvt_pk_bf16_f32 v253, v90, v91
    v_cvt_pk_bf16_f32 v254, v92, v93
    v_cvt_pk_bf16_f32 v255, v94, v95
    ds_write_b128 v15, v[252:255] offset:4096
    s_waitcnt lgkmcnt(14)
    v_mfma_f32_32x32x16_bf16 v[32:47], a[136:139], v[96:99], 0
    ds_read_b128 v[192:195], v16 offset:0
    ds_read_b128 v[196:199], v16 offset:1024
    v_sub_f32 v163, v147, v231
    v_add_f32 v147, v147, v231
    v_accvgpr_read_b32 v132, a188
    v_accvgpr_read_b32 v230, a204
    v_mfma_f32_32x32x16_bf16 v[48:63], a[136:139], v[100:103], 0
    ds_read_b128 v[200:203], v16 offset:2048
    ds_read_b128 v[204:207], v16 offset:3072
    v_accvgpr_read_b32 v148, a220
    v_accvgpr_read_b32 v231, a236
    v_sub_f32 v180, v132, v230
    v_add_f32 v132, v132, v230
    v_mfma_f32_32x32x16_bf16 v[64:79], a[140:143], v[96:99], 0
    ds_read_b128 v[208:211], v17 offset:4096
    ds_read_b128 v[212:215], v17 offset:5120
    v_sub_f32 v164, v148, v231
    v_add_f32 v148, v148, v231
    v_accvgpr_read_b32 v133, a189
    v_accvgpr_read_b32 v230, a205
    v_mfma_f32_32x32x16_bf16 v[80:95], a[140:143], v[100:103], 0
    ds_read_b128 v[216:219], v17 offset:6144
    ds_read_b128 v[220:223], v17 offset:7168
    v_accvgpr_read_b32 v149, a221
    v_accvgpr_read_b32 v231, a237
    v_sub_f32 v181, v133, v230
    s_waitcnt lgkmcnt(15)
    v_mfma_f32_32x32x16_bf16 v[32:47], a[152:155], v[104:107], v[32:47]
    s_add_u32 s58, s39, 0
    s_waitcnt lgkmcnt(4)
    buffer_store_dwordx4 v[192:195], v18, s[20:23], s58 offen sc1
    v_add_f32 v133, v133, v230
    v_sub_f32 v165, v149, v231
    v_add_f32 v149, v149, v231
    v_mfma_f32_32x32x16_bf16 v[48:63], a[152:155], v[108:111], v[48:63]
    v_accvgpr_read_b32 v134, a190
    v_accvgpr_read_b32 v230, a206
    v_accvgpr_read_b32 v150, a222
    v_accvgpr_read_b32 v231, a238
    v_sub_f32 v182, v134, v230
    v_add_f32 v134, v134, v230
    v_mfma_f32_32x32x16_bf16 v[64:79], a[156:159], v[104:107], v[64:79]
    s_add_u32 s58, s39, 524288
    v_sub_f32 v166, v150, v231
    v_add_f32 v150, v150, v231
    v_accvgpr_read_b32 v135, a191
    v_accvgpr_read_b32 v230, a207
    v_accvgpr_read_b32 v151, a223
    v_mfma_f32_32x32x16_bf16 v[80:95], a[156:159], v[108:111], v[80:95]
    buffer_store_dwordx4 v[196:199], v18, s[20:23], s58 offen sc1
    s_branch L_ld_p3
.p2align 12
L_st_p3:
L_wP_p3:
    s_branch L_retP
L_ld_p3:
    v_accvgpr_read_b32 v231, a239
    v_sub_f32 v183, v135, v230
    v_add_f32 v135, v135, v230
    v_mfma_f32_32x32x16_bf16 v[32:47], a[168:171], v[112:115], v[32:47]
    v_sub_f32 v167, v151, v231
    v_add_f32 v151, v151, v231
    v_accvgpr_read_b32 v136, a192
    v_accvgpr_read_b32 v230, a208
    v_accvgpr_read_b32 v152, a224
    v_accvgpr_read_b32 v231, a128
    v_mfma_f32_32x32x16_bf16 v[48:63], a[168:171], v[116:119], v[48:63]
    s_add_u32 s58, s39, 1048576
    v_sub_f32 v184, v136, v230
    v_add_f32 v136, v136, v230
    v_sub_f32 v168, v152, v231
    v_add_f32 v152, v152, v231
    v_accvgpr_read_b32 v137, a193
    v_mfma_f32_32x32x16_bf16 v[64:79], a[172:175], v[112:115], v[64:79]
    buffer_store_dwordx4 v[200:203], v18, s[20:23], s58 offen sc1
    v_accvgpr_read_b32 v230, a209
    v_accvgpr_read_b32 v153, a225
    v_accvgpr_read_b32 v231, a129
    v_sub_f32 v185, v137, v230
    v_mfma_f32_32x32x16_bf16 v[80:95], a[172:175], v[116:119], v[80:95]
    v_add_f32 v137, v137, v230
    v_sub_f32 v169, v153, v231
    v_add_f32 v153, v153, v231
    v_accvgpr_read_b32 v138, a194
    v_accvgpr_read_b32 v230, a210
    v_mfma_f32_32x32x16_bf16 v[32:47], a[240:243], v[120:123], v[32:47]
    s_add_u32 s58, s39, 1572864
    v_accvgpr_read_b32 v154, a226
    v_accvgpr_read_b32 v231, a130
    v_sub_f32 v186, v138, v230
    v_add_f32 v138, v138, v230
    v_sub_f32 v170, v154, v231
    v_mfma_f32_32x32x16_bf16 v[48:63], a[240:243], v[124:127], v[48:63]
    buffer_store_dwordx4 v[204:207], v18, s[20:23], s58 offen sc1
    v_add_f32 v154, v154, v231
    v_accvgpr_read_b32 v139, a195
    v_accvgpr_read_b32 v230, a211
    v_accvgpr_read_b32 v155, a227
    v_mfma_f32_32x32x16_bf16 v[64:79], a[244:247], v[120:123], v[64:79]
    v_accvgpr_read_b32 v231, a131
    v_sub_f32 v187, v139, v230
    v_add_f32 v139, v139, v230
    v_sub_f32 v171, v155, v231
    v_add_f32 v155, v155, v231
    v_accvgpr_read_b32 v140, a196
    v_mfma_f32_32x32x16_bf16 v[80:95], a[244:247], v[124:127], v[80:95]
    v_accvgpr_read_b32 v230, a212
    v_accvgpr_read_b32 v156, a228
    v_accvgpr_read_b32 v231, a132
    v_sub_f32 v188, v140, v230
    v_add_f32 v140, v140, v230
    v_sub_f32 v172, v156, v231
    v_add_f32 v156, v156, v231
    v_accvgpr_read_b32 v141, a197
    v_accvgpr_read_b32 v230, a213
    v_accvgpr_read_b32 v157, a229
    v_accvgpr_read_b32 v231, a133
    v_sub_f32 v189, v141, v230
    v_add_f32 v141, v141, v230
    v_sub_f32 v173, v157, v231
    v_add_f32 v157, v157, v231
    v_accvgpr_read_b32 v142, a198
    v_accvgpr_read_b32 v230, a214
    v_accvgpr_read_b32 v158, a230
    v_accvgpr_read_b32 v231, a134
    v_sub_f32 v190, v142, v230
    v_add_f32 v142, v142, v230
    v_sub_f32 v174, v158, v231
    v_add_f32 v158, v158, v231
    v_accvgpr_read_b32 v143, a199
    v_accvgpr_read_b32 v230, a215
    v_accvgpr_read_b32 v159, a231
    v_accvgpr_read_b32 v231, a135
    v_sub_f32 v191, v143, v230
    v_add_f32 v143, v143, v230
    v_sub_f32 v175, v159, v231
    v_add_f32 v159, v159, v231
    v_pk_mul_f32 v[232:233], v[32:33], v[128:129]
    v_pk_mul_f32 v[234:235], v[48:49], v[128:129]
    s_add_u32 s58, s39, 256
    s_waitcnt lgkmcnt(0)
    buffer_store_dwordx4 v[208:211], v18, s[20:23], s58 offen sc1
    v_pk_mul_f32 v[236:237], v[64:65], v[224:225]
    v_pk_mul_f32 v[238:239], v[80:81], v[224:225]
    v_pk_fma_f32 v[232:233], v[48:49], v[144:145], v[232:233]
    v_pk_fma_f32 v[234:235], v[32:33], v[144:145], v[234:235] neg_lo:[1,0,0] neg_hi:[1,0,0]
    v_pk_fma_f32 v[236:237], v[80:81], v[226:227], v[236:237]
    v_pk_fma_f32 v[238:239], v[64:65], v[226:227], v[238:239] neg_lo:[1,0,0] neg_hi:[1,0,0]
    v_pk_fma_f32 v[232:233], v[64:65], v[160:161], v[232:233]
    v_pk_fma_f32 v[234:235], v[80:81], v[160:161], v[234:235]
    v_pk_fma_f32 v[236:237], v[32:33], v[160:161], v[236:237] neg_lo:[1,0,0] neg_hi:[1,0,0]
    v_pk_fma_f32 v[238:239], v[48:49], v[160:161], v[238:239] neg_lo:[1,0,0] neg_hi:[1,0,0]
    v_pk_fma_f32 v[232:233], v[80:81], v[176:177], v[232:233] neg_lo:[1,0,0] neg_hi:[1,0,0]
    v_pk_fma_f32 v[234:235], v[64:65], v[176:177], v[234:235]
    v_pk_fma_f32 v[236:237], v[48:49], v[176:177], v[236:237]
    v_pk_fma_f32 v[238:239], v[32:33], v[176:177], v[238:239] neg_lo:[1,0,0] neg_hi:[1,0,0]
    v_cvt_pk_bf16_f32 v96, v232, v236
    s_add_u32 s58, s39, 524544
    buffer_store_dwordx4 v[212:215], v18, s[20:23], s58 offen sc1
    v_cvt_pk_bf16_f32 v97, v233, v237
    v_cvt_pk_bf16_f32 v112, v234, v238
    v_cvt_pk_bf16_f32 v113, v235, v239
    v_pk_mul_f32 v[240:241], v[34:35], v[130:131]
    v_pk_mul_f32 v[242:243], v[50:51], v[130:131]
    v_pk_mul_f32 v[244:245], v[66:67], v[130:131]
    v_pk_mul_f32 v[246:247], v[82:83], v[130:131]
    v_pk_fma_f32 v[240:241], v[50:51], v[146:147], v[240:241]
    v_pk_fma_f32 v[242:243], v[34:35], v[146:147], v[242:243] neg_lo:[1,0,0] neg_hi:[1,0,0]
    v_pk_fma_f32 v[244:245], v[82:83], v[146:147], v[244:245]
    v_pk_fma_f32 v[246:247], v[66:67], v[146:147], v[246:247] neg_lo:[1,0,0] neg_hi:[1,0,0]
    v_pk_fma_f32 v[240:241], v[66:67], v[162:163], v[240:241]
    v_pk_fma_f32 v[242:243], v[82:83], v[162:163], v[242:243]
    v_pk_fma_f32 v[244:245], v[34:35], v[162:163], v[244:245] neg_lo:[1,0,0] neg_hi:[1,0,0]
    v_pk_fma_f32 v[246:247], v[50:51], v[162:163], v[246:247] neg_lo:[1,0,0] neg_hi:[1,0,0]
    s_add_u32 s58, s39, 1048832
    buffer_store_dwordx4 v[216:219], v18, s[20:23], s58 offen sc1
    v_pk_fma_f32 v[240:241], v[82:83], v[178:179], v[240:241] neg_lo:[1,0,0] neg_hi:[1,0,0]
    v_pk_fma_f32 v[242:243], v[66:67], v[178:179], v[242:243]
    v_pk_fma_f32 v[244:245], v[50:51], v[178:179], v[244:245]
    v_pk_fma_f32 v[246:247], v[34:35], v[178:179], v[246:247] neg_lo:[1,0,0] neg_hi:[1,0,0]
    v_cvt_pk_bf16_f32 v98, v240, v244
    v_cvt_pk_bf16_f32 v99, v241, v245
    v_cvt_pk_bf16_f32 v114, v242, v246
    v_cvt_pk_bf16_f32 v115, v243, v247
    v_pk_mul_f32 v[232:233], v[36:37], v[132:133]
    v_pk_mul_f32 v[234:235], v[52:53], v[132:133]
    v_pk_mul_f32 v[236:237], v[68:69], v[132:133]
    v_pk_mul_f32 v[238:239], v[84:85], v[132:133]
    v_pk_fma_f32 v[232:233], v[52:53], v[148:149], v[232:233]
    v_pk_fma_f32 v[234:235], v[36:37], v[148:149], v[234:235] neg_lo:[1,0,0] neg_hi:[1,0,0]
    v_pk_fma_f32 v[236:237], v[84:85], v[148:149], v[236:237]
    s_add_u32 s58, s39, 1573120
    buffer_store_dwordx4 v[220:223], v18, s[20:23], s58 offen sc1
    v_pk_fma_f32 v[238:239], v[68:69], v[148:149], v[238:239] neg_lo:[1,0,0] neg_hi:[1,0,0]
    v_pk_fma_f32 v[232:233], v[68:69], v[164:165], v[232:233]
    v_pk_fma_f32 v[234:235], v[84:85], v[164:165], v[234:235]
    v_pk_fma_f32 v[236:237], v[36:37], v[164:165], v[236:237] neg_lo:[1,0,0] neg_hi:[1,0,0]
    v_pk_fma_f32 v[238:239], v[52:53], v[164:165], v[238:239] neg_lo:[1,0,0] neg_hi:[1,0,0]
    v_pk_fma_f32 v[232:233], v[84:85], v[180:181], v[232:233] neg_lo:[1,0,0] neg_hi:[1,0,0]
    v_pk_fma_f32 v[234:235], v[68:69], v[180:181], v[234:235]
    v_pk_fma_f32 v[236:237], v[52:53], v[180:181], v[236:237]
    v_pk_fma_f32 v[238:239], v[36:37], v[180:181], v[238:239] neg_lo:[1,0,0] neg_hi:[1,0,0]
    v_cvt_pk_bf16_f32 v100, v232, v236
    v_cvt_pk_bf16_f32 v101, v233, v237
    v_cvt_pk_bf16_f32 v116, v234, v238
    v_cvt_pk_bf16_f32 v117, v235, v239
    v_pk_mul_f32 v[240:241], v[38:39], v[134:135]
    v_pk_mul_f32 v[242:243], v[54:55], v[134:135]
    buffer_load_dwordx4 a[100:103], v1, s[20:23], s37 offen offset:1024 sc1
    v_pk_mul_f32 v[244:245], v[70:71], v[134:135]
    v_pk_mul_f32 v[246:247], v[86:87], v[134:135]
    v_pk_fma_f32 v[240:241], v[54:55], v[150:151], v[240:241]
    v_pk_fma_f32 v[242:243], v[38:39], v[150:151], v[242:243] neg_lo:[1,0,0] neg_hi:[1,0,0]
    v_pk_fma_f32 v[244:245], v[86:87], v[150:151], v[244:245]
    v_pk_fma_f32 v[246:247], v[70:71], v[150:151], v[246:247] neg_lo:[1,0,0] neg_hi:[1,0,0]
    v_pk_fma_f32 v[240:241], v[70:71], v[166:167], v[240:241]
    v_pk_fma_f32 v[242:243], v[86:87], v[166:167], v[242:243]
    v_pk_fma_f32 v[244:245], v[38:39], v[166:167], v[244:245] neg_lo:[1,0,0] neg_hi:[1,0,0]
    v_pk_fma_f32 v[246:247], v[54:55], v[166:167], v[246:247] neg_lo:[1,0,0] neg_hi:[1,0,0]
    v_pk_fma_f32 v[240:241], v[86:87], v[182:183], v[240:241] neg_lo:[1,0,0] neg_hi:[1,0,0]
    v_pk_fma_f32 v[242:243], v[70:71], v[182:183], v[242:243]
    v_pk_fma_f32 v[244:245], v[54:55], v[182:183], v[244:245]
    v_pk_fma_f32 v[246:247], v[38:39], v[182:183], v[246:247] neg_lo:[1,0,0] neg_hi:[1,0,0]
    v_cvt_pk_bf16_f32 v102, v240, v244
    s_add_u32 s37, s15, s12
    buffer_load_dwordx4 a[104:107], v1, s[20:23], s37 offen offset:0 sc1
    v_cvt_pk_bf16_f32 v103, v241, v245
    v_cvt_pk_bf16_f32 v118, v242, v246
    v_cvt_pk_bf16_f32 v119, v243, v247
    v_pk_mul_f32 v[232:233], v[40:41], v[136:137]
    v_pk_mul_f32 v[234:235], v[56:57], v[136:137]
    v_pk_mul_f32 v[236:237], v[72:73], v[136:137]
    v_pk_mul_f32 v[238:239], v[88:89], v[136:137]
    v_pk_fma_f32 v[232:233], v[56:57], v[152:153], v[232:233]
    v_pk_fma_f32 v[234:235], v[40:41], v[152:153], v[234:235] neg_lo:[1,0,0] neg_hi:[1,0,0]
    v_pk_fma_f32 v[236:237], v[88:89], v[152:153], v[236:237]
    v_pk_fma_f32 v[238:239], v[72:73], v[152:153], v[238:239] neg_lo:[1,0,0] neg_hi:[1,0,0]
    v_pk_fma_f32 v[232:233], v[72:73], v[168:169], v[232:233]
    v_pk_fma_f32 v[234:235], v[88:89], v[168:169], v[234:235]
    v_pk_fma_f32 v[236:237], v[40:41], v[168:169], v[236:237] neg_lo:[1,0,0] neg_hi:[1,0,0]
    v_pk_fma_f32 v[238:239], v[56:57], v[168:169], v[238:239] neg_lo:[1,0,0] neg_hi:[1,0,0]
    buffer_load_dwordx4 a[108:111], v1, s[20:23], s37 offen offset:1024 sc1
    v_pk_fma_f32 v[232:233], v[88:89], v[184:185], v[232:233] neg_lo:[1,0,0] neg_hi:[1,0,0]
    v_pk_fma_f32 v[234:235], v[72:73], v[184:185], v[234:235]
    v_pk_fma_f32 v[236:237], v[56:57], v[184:185], v[236:237]
    v_pk_fma_f32 v[238:239], v[40:41], v[184:185], v[238:239] neg_lo:[1,0,0] neg_hi:[1,0,0]
    v_cvt_pk_bf16_f32 v104, v232, v236
    v_cvt_pk_bf16_f32 v105, v233, v237
    v_cvt_pk_bf16_f32 v120, v234, v238
    v_cvt_pk_bf16_f32 v121, v235, v239
    v_pk_mul_f32 v[240:241], v[42:43], v[138:139]
    v_pk_mul_f32 v[242:243], v[58:59], v[138:139]
    v_pk_mul_f32 v[244:245], v[74:75], v[138:139]
    v_pk_mul_f32 v[246:247], v[90:91], v[138:139]
    v_pk_fma_f32 v[240:241], v[58:59], v[154:155], v[240:241]
    v_pk_fma_f32 v[242:243], v[42:43], v[154:155], v[242:243] neg_lo:[1,0,0] neg_hi:[1,0,0]
    v_pk_fma_f32 v[244:245], v[90:91], v[154:155], v[244:245]
    s_add_u32 s37, s15, s13
    buffer_load_dwordx4 a[112:115], v1, s[20:23], s37 offen offset:0 sc1
    v_pk_fma_f32 v[246:247], v[74:75], v[154:155], v[246:247] neg_lo:[1,0,0] neg_hi:[1,0,0]
    v_pk_fma_f32 v[240:241], v[74:75], v[170:171], v[240:241]
    v_pk_fma_f32 v[242:243], v[90:91], v[170:171], v[242:243]
    v_pk_fma_f32 v[244:245], v[42:43], v[170:171], v[244:245] neg_lo:[1,0,0] neg_hi:[1,0,0]
    v_pk_fma_f32 v[246:247], v[58:59], v[170:171], v[246:247] neg_lo:[1,0,0] neg_hi:[1,0,0]
    v_pk_fma_f32 v[240:241], v[90:91], v[186:187], v[240:241] neg_lo:[1,0,0] neg_hi:[1,0,0]
    v_pk_fma_f32 v[242:243], v[74:75], v[186:187], v[242:243]
    v_pk_fma_f32 v[244:245], v[58:59], v[186:187], v[244:245]
    v_pk_fma_f32 v[246:247], v[42:43], v[186:187], v[246:247] neg_lo:[1,0,0] neg_hi:[1,0,0]
    v_cvt_pk_bf16_f32 v106, v240, v244
    v_cvt_pk_bf16_f32 v107, v241, v245
    v_cvt_pk_bf16_f32 v122, v242, v246
    v_cvt_pk_bf16_f32 v123, v243, v247
    v_pk_mul_f32 v[232:233], v[44:45], v[140:141]
    v_pk_mul_f32 v[234:235], v[60:61], v[140:141]
    buffer_load_dwordx4 a[116:119], v1, s[20:23], s37 offen offset:1024 sc1
    v_pk_mul_f32 v[236:237], v[76:77], v[140:141]
    v_pk_mul_f32 v[238:239], v[92:93], v[140:141]
    v_pk_fma_f32 v[232:233], v[60:61], v[156:157], v[232:233]
    v_pk_fma_f32 v[234:235], v[44:45], v[156:157], v[234:235] neg_lo:[1,0,0] neg_hi:[1,0,0]
    v_pk_fma_f32 v[236:237], v[92:93], v[156:157], v[236:237]
    v_pk_fma_f32 v[238:239], v[76:77], v[156:157], v[238:239] neg_lo:[1,0,0] neg_hi:[1,0,0]
    v_pk_fma_f32 v[232:233], v[76:77], v[172:173], v[232:233]
    v_pk_fma_f32 v[234:235], v[92:93], v[172:173], v[234:235]
    v_pk_fma_f32 v[236:237], v[44:45], v[172:173], v[236:237] neg_lo:[1,0,0] neg_hi:[1,0,0]
    v_pk_fma_f32 v[238:239], v[60:61], v[172:173], v[238:239] neg_lo:[1,0,0] neg_hi:[1,0,0]
    v_pk_fma_f32 v[232:233], v[92:93], v[188:189], v[232:233] neg_lo:[1,0,0] neg_hi:[1,0,0]
    v_pk_fma_f32 v[234:235], v[76:77], v[188:189], v[234:235]
    v_pk_fma_f32 v[236:237], v[60:61], v[188:189], v[236:237]
    v_pk_fma_f32 v[238:239], v[44:45], v[188:189], v[238:239] neg_lo:[1,0,0] neg_hi:[1,0,0]
    v_cvt_pk_bf16_f32 v108, v232, v236
    s_mul_i32 s63, s64, 896
    s_add_u32 s63, s63, 0
    buffer_load_dwordx2 v[30:31], v5, s[20:23], s63 offen sc1
    v_cvt_pk_bf16_f32 v109, v233, v237
    v_cvt_pk_bf16_f32 v124, v234, v238
    v_cvt_pk_bf16_f32 v125, v235, v239
    v_pk_mul_f32 v[240:241], v[46:47], v[142:143]
    v_pk_mul_f32 v[242:243], v[62:63], v[142:143]
    v_pk_mul_f32 v[244:245], v[78:79], v[142:143]
    v_pk_mul_f32 v[246:247], v[94:95], v[142:143]
    v_pk_fma_f32 v[240:241], v[62:63], v[158:159], v[240:241]
    v_pk_fma_f32 v[242:243], v[46:47], v[158:159], v[242:243] neg_lo:[1,0,0] neg_hi:[1,0,0]
    v_pk_fma_f32 v[244:245], v[94:95], v[158:159], v[244:245]
    v_pk_fma_f32 v[246:247], v[78:79], v[158:159], v[246:247] neg_lo:[1,0,0] neg_hi:[1,0,0]
    v_pk_fma_f32 v[240:241], v[78:79], v[174:175], v[240:241]
    v_pk_fma_f32 v[242:243], v[94:95], v[174:175], v[242:243]
    v_pk_fma_f32 v[244:245], v[46:47], v[174:175], v[244:245] neg_lo:[1,0,0] neg_hi:[1,0,0]
    v_pk_fma_f32 v[246:247], v[62:63], v[174:175], v[246:247] neg_lo:[1,0,0] neg_hi:[1,0,0]
    v_pk_fma_f32 v[240:241], v[94:95], v[190:191], v[240:241] neg_lo:[1,0,0] neg_hi:[1,0,0]
    v_pk_fma_f32 v[242:243], v[78:79], v[190:191], v[242:243]
    v_pk_fma_f32 v[244:245], v[62:63], v[190:191], v[244:245]
    v_pk_fma_f32 v[246:247], v[46:47], v[190:191], v[246:247] neg_lo:[1,0,0] neg_hi:[1,0,0]
    v_cvt_pk_bf16_f32 v110, v240, v244
    v_cvt_pk_bf16_f32 v111, v241, v245
    v_cvt_pk_bf16_f32 v126, v242, v246
    v_cvt_pk_bf16_f32 v127, v243, v247
    v_mfma_f32_32x32x16_bf16 v[32:47], v[96:99], a[144:147], 0
    v_mfma_f32_32x32x16_bf16 v[32:47], v[100:103], a[160:163], v[32:47]
    v_mfma_f32_32x32x16_bf16 v[32:47], v[104:107], a[176:179], v[32:47]
    v_mfma_f32_32x32x16_bf16 v[32:47], v[108:111], a[248:251], v[32:47]
    v_mfma_f32_32x32x16_bf16 v[48:63], v[112:115], a[144:147], 0
    v_mfma_f32_32x32x16_bf16 v[48:63], v[116:119], a[160:163], v[48:63]
    s_nop 9
    v_cvt_pk_bf16_f32 v248, v32, v33
    v_cvt_pk_bf16_f32 v249, v34, v35
    v_cvt_pk_bf16_f32 v250, v36, v37
    v_cvt_pk_bf16_f32 v251, v38, v39
    v_mfma_f32_32x32x16_bf16 v[48:63], v[120:123], a[176:179], v[48:63]
    ds_write_b128 v12, v[248:251] offset:8192
    v_cvt_pk_bf16_f32 v252, v40, v41
    v_mfma_f32_32x32x16_bf16 v[48:63], v[124:127], a[248:251], v[48:63]
    v_cvt_pk_bf16_f32 v253, v42, v43
    v_cvt_pk_bf16_f32 v254, v44, v45
    v_cvt_pk_bf16_f32 v255, v46, v47
    v_mfma_f32_32x32x16_bf16 v[64:79], v[96:99], a[148:151], 0
    ds_write_b128 v13, v[252:255] offset:8192
    v_mfma_f32_32x32x16_bf16 v[64:79], v[100:103], a[164:167], v[64:79]
    s_nop 5
    v_cvt_pk_bf16_f32 v248, v48, v49
    v_cvt_pk_bf16_f32 v249, v50, v51
    v_cvt_pk_bf16_f32 v250, v52, v53
    v_cvt_pk_bf16_f32 v251, v54, v55
    v_mfma_f32_32x32x16_bf16 v[64:79], v[104:107], a[180:183], v[64:79]
    ds_write_b128 v14, v[248:251] offset:8192
    v_cvt_pk_bf16_f32 v252, v56, v57
    v_mfma_f32_32x32x16_bf16 v[64:79], v[108:111], a[252:255], v[64:79]
    v_cvt_pk_bf16_f32 v253, v58, v59
    v_cvt_pk_bf16_f32 v254, v60, v61
    v_cvt_pk_bf16_f32 v255, v62, v63
    v_mfma_f32_32x32x16_bf16 v[80:95], v[112:115], a[148:151], 0
    ds_write_b128 v15, v[252:255] offset:8192
    v_mfma_f32_32x32x16_bf16 v[80:95], v[116:119], a[164:167], v[80:95]
    s_nop 5
    v_cvt_pk_bf16_f32 v248, v64, v65
    v_cvt_pk_bf16_f32 v249, v66, v67
    v_cvt_pk_bf16_f32 v250, v68, v69
    v_cvt_pk_bf16_f32 v251, v70, v71
    v_mfma_f32_32x32x16_bf16 v[80:95], v[120:123], a[180:183], v[80:95]
    ds_write_b128 v12, v[248:251] offset:12288
    v_cvt_pk_bf16_f32 v252, v72, v73
    v_mfma_f32_32x32x16_bf16 v[80:95], v[124:127], a[252:255], v[80:95]
    v_cvt_pk_bf16_f32 v253, v74, v75
    v_cvt_pk_bf16_f32 v254, v76, v77
    v_cvt_pk_bf16_f32 v255, v78, v79
    ds_write_b128 v13, v[252:255] offset:12288
    ds_read_b128 v[128:131], v16 offset:8192
    ds_read_b128 v[132:135], v16 offset:9216
    ds_read_b128 v[136:139], v16 offset:10240
    ds_read_b128 v[140:143], v16 offset:11264
    s_nop 3
    v_cvt_pk_bf16_f32 v248, v80, v81
    v_cvt_pk_bf16_f32 v249, v82, v83
    v_cvt_pk_bf16_f32 v250, v84, v85
    v_cvt_pk_bf16_f32 v251, v86, v87
    ds_write_b128 v14, v[248:251] offset:12288
    v_cvt_pk_bf16_f32 v252, v88, v89
    v_cvt_pk_bf16_f32 v253, v90, v91
    v_cvt_pk_bf16_f32 v254, v92, v93
    v_cvt_pk_bf16_f32 v255, v94, v95
    ds_write_b128 v15, v[252:255] offset:12288
    ds_read_b128 v[144:147], v17 offset:12288
    ds_read_b128 v[148:151], v17 offset:13312
    ds_read_b128 v[152:155], v17 offset:14336
    ds_read_b128 v[156:159], v17 offset:15360
    s_add_u32 s58, s39, 16384
    s_waitcnt lgkmcnt(9)
    buffer_store_dwordx4 v[128:131], v18, s[20:23], s58 offen sc1
    s_add_u32 s58, s39, 540672
    s_waitcnt lgkmcnt(8)
    buffer_store_dwordx4 v[132:135], v18, s[20:23], s58 offen sc1
    s_add_u32 s58, s39, 1064960
    s_waitcnt lgkmcnt(7)
    buffer_store_dwordx4 v[136:139], v18, s[20:23], s58 offen sc1
    s_add_u32 s58, s39, 1589248
    s_waitcnt lgkmcnt(6)
    buffer_store_dwordx4 v[140:143], v18, s[20:23], s58 offen sc1
    s_add_u32 s58, s39, 16640
    s_waitcnt lgkmcnt(3)
    buffer_store_dwordx4 v[144:147], v18, s[20:23], s58 offen sc1
    s_add_u32 s58, s39, 540928
    s_waitcnt lgkmcnt(2)
    buffer_store_dwordx4 v[148:151], v18, s[20:23], s58 offen sc1
    s_add_u32 s58, s39, 1065216
    s_waitcnt lgkmcnt(1)
    buffer_store_dwordx4 v[152:155], v18, s[20:23], s58 offen sc1
    s_add_u32 s58, s39, 1589504
    s_waitcnt lgkmcnt(0)
    buffer_store_dwordx4 v[156:159], v18, s[20:23], s58 offen sc1
    s_add_u32 s59, s56, 65536
    v_add_u32 v8, s59, v1
    s_add_u32 s59, s52, 131072
    v_add_u32 v9, s59, v1
    s_waitcnt vmcnt(33)
    ds_read_b128 v[160:163], v8 offset:0
    ds_read_b128 v[164:167], v8 offset:1024
    ds_read_b128 v[168:171], v8 offset:2048
    ds_read_b128 v[172:175], v8 offset:3072
    ds_read_b128 v[176:179], v8 offset:4096
    ds_read_b128 v[180:183], v8 offset:5120
    ds_read_b128 v[184:187], v8 offset:6144
    ds_read_b128 v[188:191], v8 offset:7168
    ds_read_b128 v[192:195], v8 offset:8192
    ds_read_b128 v[196:199], v8 offset:9216
    ds_read_b128 v[200:203], v8 offset:10240
    ds_read_b128 v[204:207], v8 offset:11264
    ds_read_b128 v[208:211], v8 offset:12288
    ds_read_b128 v[212:215], v8 offset:13312
    ds_read_b128 v[216:219], v8 offset:14336
    ds_read_b128 v[220:223], v8 offset:15360
    s_waitcnt vmcnt(8)
    v_cmp_ne_u64 vcc, s[40:41], v[30:31]
    s_nop 0
    s_and_b32 s68, vcc_lo, 3
    s_cbranch_scc1 L_pr8
L_pd8:
    s_barrier
    s_mul_i32 s51, s64, 14336
    s_add_u32 s51, s51, s33
    s_add_u32 s55, s51, s8
    buffer_load_dwordx4 a[16:19], v1, s[20:23], s55 offen offset:0 sc1
    buffer_load_dwordx4 a[20:23], v1, s[20:23], s55 offen offset:1024 sc1
    s_add_u32 s55, s51, s9
    buffer_load_dwordx4 a[24:27], v1, s[20:23], s55 offen offset:0 sc1
    buffer_load_dwordx4 a[28:31], v1, s[20:23], s55 offen offset:1024 sc1
    s_add_u32 s55, s51, s10
    buffer_load_dwordx4 a[32:35], v1, s[20:23], s55 offen offset:0 sc1
    buffer_load_dwordx4 a[36:39], v1, s[20:23], s55 offen offset:1024 sc1
    s_add_u32 s55, s51, s11
    buffer_load_dwordx4 a[40:43], v1, s[20:23], s55 offen offset:0 sc1
    buffer_load_dwordx4 a[44:47], v1, s[20:23], s55 offen offset:1024 sc1
    s_add_u32 s55, s51, s12
    buffer_load_dwordx4 a[48:51], v1, s[20:23], s55 offen offset:0 sc1
    buffer_load_dwordx4 a[52:55], v1, s[20:23], s55 offen offset:1024 sc1
    s_waitcnt vmcnt(10)
    s_barrier
    buffer_store_dwordx2 v[6:7], v2, s[20:23], s54 offen sc1
    s_mul_i32 s63, s65, 896
    s_add_u32 s63, s63, 3584
    buffer_load_dwordx2 v[30:31], v5, s[20:23], s63 offen sc1
    s_add_u32 s55, s51, s13
    buffer_load_dwordx4 a[56:59], v1, s[20:23], s55 offen offset:0 sc1
    buffer_load_dwordx4 a[60:63], v1, s[20:23], s55 offen offset:1024 sc1
    s_add_u32 s55, s51, s14
    buffer_load_dwordx4 a[64:67], v1, s[20:23], s55 offen offset:0 sc1
    buffer_load_dwordx4 a[68:71], v1, s[20:23], s55 offen offset:1024 sc1
    s_mul_i32 s15, s65, 14336
    s_add_u32 s15, s15, s32
    s_add_u32 s37, s15, s9
    buffer_load_dwordx4 v[224:227], v1, s[20:23], s37 offen offset:0 sc1
    buffer_load_dwordx4 v[228:231], v1, s[20:23], s37 offen offset:1024 sc1
    s_add_u32 s37, s15, s10
    buffer_load_dwordx4 v[232:235], v1, s[20:23], s37 offen offset:0 sc1
    buffer_load_dwordx4 v[236:239], v1, s[20:23], s37 offen offset:1024 sc1
    s_add_u32 s37, s15, s11
    buffer_load_dwordx4 v[240:243], v1, s[20:23], s37 offen offset:0 sc1
    buffer_load_dwordx4 v[244:247], v1, s[20:23], s37 offen offset:1024 sc1
    s_add_u32 s37, s15, s12
    buffer_load_dwordx4 v[248:251], v1, s[20:23], s37 offen offset:0 sc1
    buffer_load_dwordx4 v[252:255], v1, s[20:23], s37 offen offset:1024 sc1
    s_mov_b32 s39, 0x40000000
    s_mov_b32 s34, 0x40000000
    s_mov_b32 s35, 0x40000000
    s_mov_b32 s19, 0
    s_waitcnt vmcnt(63) lgkmcnt(0)
    s_branch L_g2
L_pr1:
    s_mov_b32 s3, 100000
L_pl1:
    s_sleep 4
    buffer_load_dwordx2 v[30:31], v28, s[20:23], 0 offen sc1
    s_sub_u32 s3, s3, 1
    s_cbranch_scc1 L_pd1
    s_waitcnt vmcnt(0)
    v_cmp_ne_u64 vcc, s[40:41], v[30:31]
    s_nop 0
    s_and_b32 s68, vcc_lo, 32639
    s_cbranch_scc1 L_pl1
    s_branch L_pd1
L_pr2:
    s_mov_b32 s3, 100000
L_pl2:
    s_sleep 4
    buffer_load_dwordx2 v[30:31], v5, s[20:23], s63 offen sc1
    s_sub_u32 s3, s3, 1
    s_cbranch_scc1 L_pd2
    s_waitcnt vmcnt(0)
    v_cmp_ne_u64 vcc, s[40:41], v[30:31]
    s_nop 0
    s_and_b32 s68, vcc_lo, 3
    s_cbranch_scc1 L_pl2
    s_branch L_pd2
L_pr3:
    s_mov_b32 s3, 100000
L_pl3:
    s_sleep 4
    buffer_load_dwordx2 v[30:31], v5, s[20:23], s63 offen sc1
    s_sub_u32 s3, s3, 1
    s_cbranch_scc1 L_pd3
    s_waitcnt vmcnt(0)
    v_cmp_ne_u64 vcc, s[40:41], v[30:31]
    s_nop 0
    s_and_b32 s68, vcc_lo, 3
    s_cbranch_scc1 L_pl3
    s_branch L_pd3
L_pr4:
    s_mov_b32 s3, 100000
L_pl4:
    s_sleep 4
    buffer_load_dwordx2 v[30:31], v5, s[20:23], s63 offen sc1
    s_sub_u32 s3, s3, 1
    s_cbranch_scc1 L_pd4
    s_waitcnt vmcnt(0)
    v_cmp_ne_u64 vcc, s[40:41], v[30:31]
    s_nop 0
    s_and_b32 s68, vcc_lo, 3
    s_cbranch_scc1 L_pl4
    s_branch L_pd4
L_pr5:
    s_mov_b32 s3, 100000
L_pl5:
    s_sleep 4
    buffer_load_dwordx2 v[30:31], v28, s[20:23], 0 offen sc1
    s_sub_u32 s3, s3, 1
    s_cbranch_scc1 L_pd5
    s_waitcnt vmcnt(0)
    v_cmp_ne_u64 vcc, s[40:41], v[30:31]
    s_nop 0
    s_and_b32 s68, vcc_lo, 255
    s_cbranch_scc1 L_pl5
    s_branch L_pd5
L_pr6:
    s_mov_b32 s3, 100000
L_pl6:
    s_sleep 4
    buffer_load_dwordx2 v[30:31], v5, s[20:23], s63 offen sc1
    s_sub_u32 s3, s3, 1
    s_cbranch_scc1 L_pd6
    s_waitcnt vmcnt(0)
    v_cmp_ne_u64 vcc, s[40:41], v[30:31]
    s_nop 0
    s_and_b32 s68, vcc_lo, 3
    s_cbranch_scc1 L_pl6
    s_branch L_pd6
L_pr8:
    s_mov_b32 s3, 100000
L_pl8:
    s_sleep 4
    buffer_load_dwordx2 v[30:31], v5, s[20:23], s63 offen sc1
    s_sub_u32 s3, s3, 1
    s_cbranch_scc1 L_pd8
    s_waitcnt vmcnt(0)
    v_cmp_ne_u64 vcc, s[40:41], v[30:31]
    s_nop 0
    s_and_b32 s68, vcc_lo, 3
    s_cbranch_scc1 L_pl8
    s_branch L_pd8
L_codeend:
    s_endpgm
.section .rodata,"a"
.p2align 6
.amdhsa_kernel gated_mix__spectral_gfnet__glu_gated_geglu__prompt_kernel
  .amdhsa_next_free_vgpr 512
  .amdhsa_next_free_sgpr 102
  .amdhsa_accum_offset 256
  .amdhsa_group_segment_fixed_size 0
  .amdhsa_kernarg_size 88
  .amdhsa_user_sgpr_count 2
  .amdhsa_user_sgpr_kernarg_segment_ptr 1
  .amdhsa_system_sgpr_workgroup_id_x 1
  .amdhsa_float_denorm_mode_32 3
.end_amdhsa_kernel
```
